```python
import torch

def _softmax(x, axis=-1):
    return torch.softmax(x, dim=axis)
def _gelu(x):
    return torch.nn.functional.gelu(x, approximate="tanh")
def _silu(x):
    return torch.nn.functional.silu(x)
def _sigmoid(x):
    return torch.sigmoid(x)
def _layernorm(x, axis=-1, eps=1e-5):
    m = x.mean(dim=axis, keepdim=True)
    v = x.var(dim=axis, keepdim=True, unbiased=False)
    return (x - m) / torch.sqrt(v + eps)
def _scatter_add(tgt, idx, src, axis=0):
    return tgt.clone().index_add_(axis, idx, src)
def _segment_sum(src, seg, n):
    out = torch.zeros((n,) + src.shape[1:], dtype=src.dtype)
    return out.index_add_(0, seg, src)
def _pad(x, pw):
    flat = tuple(v for pair in reversed(pw) for v in pair)
    return torch.nn.functional.pad(x, flat)

kernel_name = 'standalone__mha_block_cached__near_ridge'

def setup_inputs():

    _w = (lambda a: (lambda t: t.to(torch.bfloat16) if t.is_floating_point() else t)(torch.as_tensor(a)))
    B, Sq, D = 8, 144, 576
    H, Sk, Dh = 32, 512, 128
    return {
        "x": _w((lambda *s: torch.randn(*s, dtype=torch.bfloat16) * 0.8)(B, Sq, D)),
        "k_cache": _w((lambda *s: torch.randn(*s, dtype=torch.bfloat16) * 0.8)(B, H, Sk, Dh)),
        "v_cache": _w((lambda *s: torch.randn(*s, dtype=torch.bfloat16) * 0.05)(B, H, Sk, Dh)),
        "wq": _w((lambda *s: torch.randn(*s, dtype=torch.bfloat16) * 0.8)(D, H * Dh) * (D ** -0.5)),
        "wo": _w((lambda *s: torch.randn(*s, dtype=torch.bfloat16) * 0.05)(H * Dh, D) * ((H * Dh) ** -0.5)),
    }

def reference(x, k_cache, v_cache, wq, wo):
    B, Sq, D = x.shape
    H, Dh = 32, 128
    q = (lambda x, *d: x.permute(*d))((x @ wq).reshape(B, Sq, H, Dh), 0, 2, 1, 3)
    scores = torch.einsum("bhqd,bhkd->bhqk", q, k_cache) * (Dh ** -0.5)
    p = _softmax(scores, axis=-1)
    o = torch.einsum("bhqk,bhkd->bhqd", p, v_cache)
    return (lambda x, *d: x.permute(*d))(o, 0, 2, 1, 3).reshape(B, Sq, H * Dh) @ wo
```

```asm
; @launch kernel=attn_kernel grid=(256,1,1) block=(512,1,1) lds=163840
; @launch kernel=oproj_kernel grid=(216,1,1) block=(512,1,1) lds=98304
.amdgcn_target "amdgcn-amd-amdhsa--gfx950"
.text
.globl attn_kernel
.p2align 8
.type attn_kernel,@function
attn_kernel:
    s_cmp_ge_u32 s2, 256
    s_cbranch_scc1 .Lk1_end
    s_load_dwordx16 s[4:19], s[0:1], 0
    v_lshrrev_b32 v1, 6, v0
    v_and_b32 v0, 63, v0
    v_readfirstlane_b32 s44, v1
    s_and_b32 s47, s2, 7
    s_lshr_b32 s48, s2, 3
    s_and_b32 s52, s48, 3
    s_lshl_b32 s52, s52, 3
    s_add_u32 s52, s52, s47
    s_lshr_b32 s51, s48, 2
    s_and_b32 s45, s44, 3
    s_lshl_b32 s46, s45, 12
    v_and_b32 v27, 15, v0
    v_lshrrev_b32 v28, 4, v0
    v_bfe_u32 v29, v0, 2, 2
    v_and_b32 v30, 3, v0
    v_lshlrev_b32 v26, 4, v0
    s_waitcnt lgkmcnt(0)
    s_mul_i32 s47, s51, 165888
    s_add_u32 s20, s4, s47
    s_addc_u32 s21, s5, 0
    s_mov_b32 s22, 165888
    s_mov_b32 s23, 0x00020000
    s_lshl_b32 s47, s51, 5
    s_add_u32 s47, s47, s52
    s_lshl_b32 s47, s47, 17
    s_add_u32 s24, s6, s47
    s_addc_u32 s25, s7, 0
    s_mov_b32 s26, 131072
    s_mov_b32 s27, 0x00020000
    s_add_u32 s28, s8, s47
    s_addc_u32 s29, s9, 0
    s_mov_b32 s30, 131072
    s_mov_b32 s31, 0x00020000
    s_lshl_b32 s47, s52, 8
    s_add_u32 s32, s10, s47
    s_addc_u32 s33, s11, 0
    s_sub_u32 s34, 4718592, s47
    s_mov_b32 s35, 0x00020000
    s_mov_b32 s36, s12
    s_mov_b32 s37, s13
    s_mov_b32 s38, 4718592
    s_mov_b32 s39, 0x00020000
    s_mov_b32 s40, s18
    s_mov_b32 s41, s19
    s_mov_b32 s42, 33554432
    s_mov_b32 s43, 0x00020000
    s_cmp_lt_u32 s44, 4
    s_cbranch_scc0 .Lk1_B
    s_lshl_b32 s47, s45, 4
    v_add_u32 v1, s47, v28
    v_add_u32 v1, 0, v1
    v_lshlrev_b32 v1, 13, v1
    v_add_u32 v2, 0, v28
    v_lshlrev_b32 v2, 1, v2
    v_xor_b32 v2, v2, v27
    v_lshl_add_u32 v2, v2, 4, v1
    v_add_u32 v1, s47, v28
    v_add_u32 v1, 4, v1
    v_lshlrev_b32 v1, 13, v1
    v_add_u32 v3, 0, v28
    v_lshlrev_b32 v3, 1, v3
    v_xor_b32 v3, v3, v27
    v_lshl_add_u32 v3, v3, 4, v1
    v_add_u32 v1, s47, v28
    v_add_u32 v1, 8, v1
    v_lshlrev_b32 v1, 13, v1
    v_add_u32 v4, 4, v28
    v_lshlrev_b32 v4, 1, v4
    v_xor_b32 v4, v4, v27
    v_lshl_add_u32 v4, v4, 4, v1
    v_add_u32 v1, s47, v28
    v_add_u32 v1, 12, v1
    v_lshlrev_b32 v1, 13, v1
    v_add_u32 v5, 4, v28
    v_lshlrev_b32 v5, 1, v5
    v_xor_b32 v5, v5, v27
    v_lshl_add_u32 v5, v5, 4, v1
    v_lshrrev_b32 v1, 3, v0
    s_lshl_b32 s47, s45, 3
    v_add_u32 v1, s47, v1
    v_mul_u32_u24 v1, 1152, v1
    s_and_b32 s47, s45, 1
    s_lshl_b32 s48, s47, 2
    v_and_b32 v6, 7, v0
    v_xor_b32 v6, v6, v28
    v_xor_b32 v6, s48, v6
    v_lshl_add_u32 v6, v6, 4, v1
    s_add_u32 s54, s47, 16
    s_sub_u32 s59, s54, s45
    s_mul_i32 s59, s59, 9216
    s_lshl_b32 s54, s54, 10
    s_lshl_b32 s58, s45, 10
    s_mov_b32 s3, 0
    s_lshl_b32 s14, s3, 19
    s_lshl_b32 s15, s3, 7
    s_add_u32 m0, s46, 49152
    s_nop 0
    buffer_load_dwordx4 v2, s[32:35], s14 offen nt lds
    s_add_u32 m0, s46, 50176
    s_nop 0
    buffer_load_dwordx4 v3, s[32:35], s14 offen nt lds
    s_add_u32 m0, s46, 51200
    s_nop 0
    buffer_load_dwordx4 v4, s[32:35], s14 offen nt lds
    s_add_u32 m0, s46, 52224
    s_nop 0
    buffer_load_dwordx4 v5, s[32:35], s14 offen nt lds
    s_add_u32 m0, s58, 65536
    s_add_u32 s57, s15, 0
    buffer_load_dwordx4 v6, s[20:23], s57 offen  lds
    s_add_u32 m0, s58, 69632
    s_add_u32 s57, s15, 36864
    buffer_load_dwordx4 v6, s[20:23], s57 offen  lds
    s_add_u32 m0, s58, 73728
    s_add_u32 s57, s15, 73728
    buffer_load_dwordx4 v6, s[20:23], s57 offen  lds
    s_add_u32 m0, s58, 77824
    s_add_u32 s57, s15, 110592
    buffer_load_dwordx4 v6, s[20:23], s57 offen  lds
    s_add_u32 m0, s54, 65536
    s_add_u32 s57, s59, s15
    buffer_load_dwordx4 v6, s[20:23], s57 offen  lds
    s_add_u32 s3, s3, 1
    s_cmp_eq_u32 s3, 9
    s_cselect_b32 s3, 0, s3
    s_lshl_b32 s14, s3, 19
    s_lshl_b32 s15, s3, 7
    s_add_u32 m0, s46, 83968
    s_nop 0
    buffer_load_dwordx4 v2, s[32:35], s14 offen nt lds
    s_add_u32 m0, s46, 84992
    s_nop 0
    buffer_load_dwordx4 v3, s[32:35], s14 offen nt lds
    s_add_u32 m0, s46, 86016
    s_nop 0
    buffer_load_dwordx4 v4, s[32:35], s14 offen nt lds
    s_add_u32 m0, s46, 87040
    s_nop 0
    buffer_load_dwordx4 v5, s[32:35], s14 offen nt lds
    s_add_u32 m0, s58, 100352
    s_add_u32 s57, s15, 0
    buffer_load_dwordx4 v6, s[20:23], s57 offen  lds
    s_add_u32 m0, s58, 104448
    s_add_u32 s57, s15, 36864
    buffer_load_dwordx4 v6, s[20:23], s57 offen  lds
    s_add_u32 m0, s58, 108544
    s_add_u32 s57, s15, 73728
    buffer_load_dwordx4 v6, s[20:23], s57 offen  lds
    s_add_u32 m0, s58, 112640
    s_add_u32 s57, s15, 110592
    buffer_load_dwordx4 v6, s[20:23], s57 offen  lds
    s_add_u32 m0, s54, 100352
    s_add_u32 s57, s59, s15
    buffer_load_dwordx4 v6, s[20:23], s57 offen  lds
    s_add_u32 s3, s3, 1
    s_cmp_eq_u32 s3, 9
    s_cselect_b32 s3, 0, s3
    s_lshl_b32 s47, s44, 8
    v_lshl_add_u32 v1, v0, 2, s47
    v_mov_b32 v8, 0xff800000
    v_add_u32 v1, 161792, v1
    ds_write_b32 v1, v8
    v_and_b32 v1, 1, v28
    v_lshl_add_u32 v31, v1, 2, v29
    v_lshl_add_u32 v1, v28, 3, v29
    v_lshlrev_b32 v1, 8, v1
    v_lshl_add_u32 v1, v30, 3, v1
    v_xor_b32 v8, 0, v31
    v_lshl_add_u32 v8, v8, 5, v1
    v_xor_b32 v9, 1, v31
    v_lshl_add_u32 v9, v9, 5, v1
    v_xor_b32 v10, 2, v31
    v_lshl_add_u32 v10, v10, 5, v1
    v_xor_b32 v11, 3, v31
    v_lshl_add_u32 v11, v11, 5, v1
    v_xor_b32 v12, s44, v31
    v_lshl_add_u32 v12, v12, 5, v1
    v_bfe_u32 v1, v27, 1, 2
    v_lshrrev_b32 v13, 3, v27
    v_lshl_add_u32 v1, v13, 2, v1
    v_xor_b32 v1, v1, v28
    v_lshlrev_b32 v1, 4, v1
    v_lshl_add_u32 v1, v13, 10, v1
    v_and_b32 v13, 7, v27
    v_lshl_add_u32 v1, v13, 7, v1
    v_add_u32 v15, 32768, v1
    v_xor_b32 v24, 64, v15
    s_lshl_b32 s47, s45, 12
    s_add_u32 s47, s47, 16384
    v_add_u32 v13, s47, v1
    v_xor_b32 v14, 64, v13
    s_waitcnt vmcnt(9)
    s_barrier
    v_add_u32 v16, 49152, v8
    v_add_u32 v17, 49152, v9
    v_add_u32 v18, 49152, v10
    v_add_u32 v19, 49152, v11
    v_add_u32 v20, 49152, v12
    v_add_u32 v21, 49152, v13
    v_add_u32 v22, 49152, v14
    v_add_u32 v23, 49152, v15
    v_add_u32 v25, 49152, v24
    ds_read_b128 v[92:95], v21
    ds_read_b128 v[96:99], v21 offset:2048
    ds_read_b64_tr_b16 v[72:73], v16 offset:0
    ds_read_b64_tr_b16 v[74:75], v16 offset:1024
    ds_read_b64_tr_b16 v[76:77], v17 offset:0
    ds_read_b64_tr_b16 v[78:79], v17 offset:1024
    ds_read_b64_tr_b16 v[80:81], v18 offset:0
    ds_read_b64_tr_b16 v[82:83], v18 offset:1024
    ds_read_b64_tr_b16 v[84:85], v19 offset:0
    ds_read_b64_tr_b16 v[86:87], v19 offset:1024
    ds_read_b64_tr_b16 v[88:89], v20 offset:0
    ds_read_b64_tr_b16 v[90:91], v20 offset:1024
    ds_read_b128 v[100:103], v23
    s_waitcnt lgkmcnt(9)
    v_mfma_f32_16x16x32_bf16 v[32:35], v[72:75], v[92:95], 0
    ds_read_b128 v[124:127], v22
    ds_read_b128 v[128:131], v22 offset:2048
    ds_read_b64_tr_b16 v[104:105], v16 offset:8192
    v_mfma_f32_16x16x32_bf16 v[36:39], v[72:75], v[96:99], 0
    ds_read_b64_tr_b16 v[106:107], v16 offset:9216
    ds_read_b64_tr_b16 v[108:109], v17 offset:8192
    s_waitcnt lgkmcnt(12)
    v_mfma_f32_16x16x32_bf16 v[40:43], v[76:79], v[92:95], 0
    ds_read_b64_tr_b16 v[110:111], v17 offset:9216
    ds_read_b64_tr_b16 v[112:113], v18 offset:8192
    v_mfma_f32_16x16x32_bf16 v[44:47], v[76:79], v[96:99], 0
    s_waitcnt lgkmcnt(12)
    v_mfma_f32_16x16x32_bf16 v[48:51], v[80:83], v[92:95], 0
    ds_read_b64_tr_b16 v[114:115], v18 offset:9216
    ds_read_b64_tr_b16 v[116:117], v19 offset:8192
    v_mfma_f32_16x16x32_bf16 v[52:55], v[80:83], v[96:99], 0
    s_waitcnt lgkmcnt(12)
    v_mfma_f32_16x16x32_bf16 v[56:59], v[84:87], v[92:95], 0
    ds_read_b64_tr_b16 v[118:119], v19 offset:9216
    ds_read_b64_tr_b16 v[120:121], v20 offset:8192
    v_mfma_f32_16x16x32_bf16 v[60:63], v[84:87], v[96:99], 0
    s_waitcnt lgkmcnt(11)
    v_mfma_f32_16x16x32_bf16 v[64:67], v[88:91], v[100:103], 0
    ds_read_b64_tr_b16 v[122:123], v20 offset:9216
    ds_read_b128 v[132:135], v25
    s_lshl_b32 s14, s3, 19
    s_lshl_b32 s15, s3, 7
    s_add_u32 m0, s46, 118784
    s_nop 0
    buffer_load_dwordx4 v2, s[32:35], s14 offen nt lds
    s_waitcnt lgkmcnt(0)
    s_add_u32 m0, s46, 119808
    s_nop 0
    buffer_load_dwordx4 v3, s[32:35], s14 offen nt lds
    s_add_u32 m0, s46, 120832
    s_nop 0
    buffer_load_dwordx4 v4, s[32:35], s14 offen nt lds
    s_add_u32 m0, s46, 121856
    s_nop 0
    buffer_load_dwordx4 v5, s[32:35], s14 offen nt lds
    s_add_u32 m0, s58, 135168
    s_add_u32 s57, s15, 0
    buffer_load_dwordx4 v6, s[20:23], s57 offen  lds
    s_add_u32 m0, s58, 139264
    s_add_u32 s57, s15, 36864
    buffer_load_dwordx4 v6, s[20:23], s57 offen  lds
    s_add_u32 m0, s58, 143360
    s_add_u32 s57, s15, 73728
    buffer_load_dwordx4 v6, s[20:23], s57 offen  lds
    s_add_u32 m0, s58, 147456
    s_add_u32 s57, s15, 110592
    buffer_load_dwordx4 v6, s[20:23], s57 offen  lds
    s_add_u32 m0, s54, 135168
    s_add_u32 s57, s59, s15
    buffer_load_dwordx4 v6, s[20:23], s57 offen  lds
    s_add_u32 s3, s3, 1
    s_cmp_eq_u32 s3, 9
    s_cselect_b32 s3, 0, s3
    s_waitcnt vmcnt(9)
    s_barrier
    v_add_u32 v16, 83968, v8
    v_add_u32 v17, 83968, v9
    v_add_u32 v18, 83968, v10
    v_add_u32 v19, 83968, v11
    v_add_u32 v20, 83968, v12
    v_add_u32 v21, 83968, v13
    v_add_u32 v22, 83968, v14
    v_add_u32 v23, 83968, v15
    v_add_u32 v25, 83968, v24
    v_mfma_f32_16x16x32_bf16 v[32:35], v[104:107], v[124:127], v[32:35]
    ds_read_b128 v[92:95], v21
    ds_read_b128 v[96:99], v21 offset:2048
    ds_read_b64_tr_b16 v[72:73], v16 offset:0
    v_mfma_f32_16x16x32_bf16 v[36:39], v[104:107], v[128:131], v[36:39]
    ds_read_b64_tr_b16 v[74:75], v16 offset:1024
    ds_read_b64_tr_b16 v[76:77], v17 offset:0
    ds_read_b64_tr_b16 v[78:79], v17 offset:1024
    v_mfma_f32_16x16x32_bf16 v[40:43], v[108:111], v[124:127], v[40:43]
    ds_read_b64_tr_b16 v[80:81], v18 offset:0
    ds_read_b64_tr_b16 v[82:83], v18 offset:1024
    ds_read_b64_tr_b16 v[84:85], v19 offset:0
    v_mfma_f32_16x16x32_bf16 v[44:47], v[108:111], v[128:131], v[44:47]
    ds_read_b64_tr_b16 v[86:87], v19 offset:1024
    ds_read_b64_tr_b16 v[88:89], v20 offset:0
    ds_read_b64_tr_b16 v[90:91], v20 offset:1024
    v_mfma_f32_16x16x32_bf16 v[48:51], v[112:115], v[124:127], v[48:51]
    ds_read_b128 v[100:103], v23
    s_lshl_b32 s14, s3, 19
    s_lshl_b32 s15, s3, 7
    s_add_u32 m0, s46, 49152
    s_nop 0
    buffer_load_dwordx4 v2, s[32:35], s14 offen nt lds
    v_mfma_f32_16x16x32_bf16 v[52:55], v[112:115], v[128:131], v[52:55]
    s_add_u32 m0, s46, 50176
    s_nop 0
    buffer_load_dwordx4 v3, s[32:35], s14 offen nt lds
    v_mfma_f32_16x16x32_bf16 v[56:59], v[116:119], v[124:127], v[56:59]
    s_add_u32 m0, s46, 51200
    s_nop 0
    buffer_load_dwordx4 v4, s[32:35], s14 offen nt lds
    v_mfma_f32_16x16x32_bf16 v[60:63], v[116:119], v[128:131], v[60:63]
    s_add_u32 m0, s46, 52224
    s_nop 0
    buffer_load_dwordx4 v5, s[32:35], s14 offen nt lds
    v_mfma_f32_16x16x32_bf16 v[64:67], v[120:123], v[132:135], v[64:67]
    s_add_u32 m0, s58, 65536
    s_add_u32 s57, s15, 0
    buffer_load_dwordx4 v6, s[20:23], s57 offen  lds
    s_waitcnt lgkmcnt(9)
    v_mfma_f32_16x16x32_bf16 v[32:35], v[72:75], v[92:95], v[32:35]
    ds_read_b128 v[124:127], v22
    ds_read_b128 v[128:131], v22 offset:2048
    ds_read_b64_tr_b16 v[104:105], v16 offset:8192
    v_mfma_f32_16x16x32_bf16 v[36:39], v[72:75], v[96:99], v[36:39]
    ds_read_b64_tr_b16 v[106:107], v16 offset:9216
    ds_read_b64_tr_b16 v[108:109], v17 offset:8192
    s_waitcnt lgkmcnt(12)
    v_mfma_f32_16x16x32_bf16 v[40:43], v[76:79], v[92:95], v[40:43]
    ds_read_b64_tr_b16 v[110:111], v17 offset:9216
    ds_read_b64_tr_b16 v[112:113], v18 offset:8192
    v_mfma_f32_16x16x32_bf16 v[44:47], v[76:79], v[96:99], v[44:47]
    s_waitcnt lgkmcnt(12)
    v_mfma_f32_16x16x32_bf16 v[48:51], v[80:83], v[92:95], v[48:51]
    ds_read_b64_tr_b16 v[114:115], v18 offset:9216
    ds_read_b64_tr_b16 v[116:117], v19 offset:8192
    v_mfma_f32_16x16x32_bf16 v[52:55], v[80:83], v[96:99], v[52:55]
    s_waitcnt lgkmcnt(12)
    v_mfma_f32_16x16x32_bf16 v[56:59], v[84:87], v[92:95], v[56:59]
    ds_read_b64_tr_b16 v[118:119], v19 offset:9216
    ds_read_b64_tr_b16 v[120:121], v20 offset:8192
    v_mfma_f32_16x16x32_bf16 v[60:63], v[84:87], v[96:99], v[60:63]
    s_waitcnt lgkmcnt(11)
    v_mfma_f32_16x16x32_bf16 v[64:67], v[88:91], v[100:103], v[64:67]
    ds_read_b64_tr_b16 v[122:123], v20 offset:9216
    ds_read_b128 v[132:135], v25
    s_add_u32 m0, s58, 69632
    s_add_u32 s57, s15, 36864
    buffer_load_dwordx4 v6, s[20:23], s57 offen  lds
    s_waitcnt lgkmcnt(0)
    s_add_u32 m0, s58, 73728
    s_add_u32 s57, s15, 73728
    buffer_load_dwordx4 v6, s[20:23], s57 offen  lds
    s_add_u32 m0, s58, 77824
    s_add_u32 s57, s15, 110592
    buffer_load_dwordx4 v6, s[20:23], s57 offen  lds
    s_add_u32 m0, s54, 65536
    s_add_u32 s57, s59, s15
    buffer_load_dwordx4 v6, s[20:23], s57 offen  lds
    s_add_u32 s3, s3, 1
    s_cmp_eq_u32 s3, 9
    s_cselect_b32 s3, 0, s3
    s_waitcnt vmcnt(9)
    s_barrier
    v_add_u32 v16, 118784, v8
    v_add_u32 v17, 118784, v9
    v_add_u32 v18, 118784, v10
    v_add_u32 v19, 118784, v11
    v_add_u32 v20, 118784, v12
    v_add_u32 v21, 118784, v13
    v_add_u32 v22, 118784, v14
    v_add_u32 v23, 118784, v15
    v_add_u32 v25, 118784, v24
    v_mfma_f32_16x16x32_bf16 v[32:35], v[104:107], v[124:127], v[32:35]
    ds_read_b128 v[92:95], v21
    ds_read_b128 v[96:99], v21 offset:2048
    ds_read_b64_tr_b16 v[72:73], v16 offset:0
    v_mfma_f32_16x16x32_bf16 v[36:39], v[104:107], v[128:131], v[36:39]
    ds_read_b64_tr_b16 v[74:75], v16 offset:1024
    ds_read_b64_tr_b16 v[76:77], v17 offset:0
    ds_read_b64_tr_b16 v[78:79], v17 offset:1024
    v_mfma_f32_16x16x32_bf16 v[40:43], v[108:111], v[124:127], v[40:43]
    ds_read_b64_tr_b16 v[80:81], v18 offset:0
    ds_read_b64_tr_b16 v[82:83], v18 offset:1024
    ds_read_b64_tr_b16 v[84:85], v19 offset:0
    v_mfma_f32_16x16x32_bf16 v[44:47], v[108:111], v[128:131], v[44:47]
    ds_read_b64_tr_b16 v[86:87], v19 offset:1024
    ds_read_b64_tr_b16 v[88:89], v20 offset:0
    ds_read_b64_tr_b16 v[90:91], v20 offset:1024
    v_mfma_f32_16x16x32_bf16 v[48:51], v[112:115], v[124:127], v[48:51]
    ds_read_b128 v[100:103], v23
    s_lshl_b32 s14, s3, 19
    s_lshl_b32 s15, s3, 7
    s_add_u32 m0, s46, 83968
    s_nop 0
    buffer_load_dwordx4 v2, s[32:35], s14 offen nt lds
    v_mfma_f32_16x16x32_bf16 v[52:55], v[112:115], v[128:131], v[52:55]
    s_add_u32 m0, s46, 84992
    s_nop 0
    buffer_load_dwordx4 v3, s[32:35], s14 offen nt lds
    v_mfma_f32_16x16x32_bf16 v[56:59], v[116:119], v[124:127], v[56:59]
    s_add_u32 m0, s46, 86016
    s_nop 0
    buffer_load_dwordx4 v4, s[32:35], s14 offen nt lds
    v_mfma_f32_16x16x32_bf16 v[60:63], v[116:119], v[128:131], v[60:63]
    s_add_u32 m0, s46, 87040
    s_nop 0
    buffer_load_dwordx4 v5, s[32:35], s14 offen nt lds
    v_mfma_f32_16x16x32_bf16 v[64:67], v[120:123], v[132:135], v[64:67]
    s_add_u32 m0, s58, 100352
    s_add_u32 s57, s15, 0
    buffer_load_dwordx4 v6, s[20:23], s57 offen  lds
    s_waitcnt lgkmcnt(9)
    v_mfma_f32_16x16x32_bf16 v[32:35], v[72:75], v[92:95], v[32:35]
    ds_read_b128 v[124:127], v22
    ds_read_b128 v[128:131], v22 offset:2048
    ds_read_b64_tr_b16 v[104:105], v16 offset:8192
    v_mfma_f32_16x16x32_bf16 v[36:39], v[72:75], v[96:99], v[36:39]
    ds_read_b64_tr_b16 v[106:107], v16 offset:9216
    ds_read_b64_tr_b16 v[108:109], v17 offset:8192
    s_waitcnt lgkmcnt(12)
    v_mfma_f32_16x16x32_bf16 v[40:43], v[76:79], v[92:95], v[40:43]
    ds_read_b64_tr_b16 v[110:111], v17 offset:9216
    ds_read_b64_tr_b16 v[112:113], v18 offset:8192
    v_mfma_f32_16x16x32_bf16 v[44:47], v[76:79], v[96:99], v[44:47]
    s_waitcnt lgkmcnt(12)
    v_mfma_f32_16x16x32_bf16 v[48:51], v[80:83], v[92:95], v[48:51]
    ds_read_b64_tr_b16 v[114:115], v18 offset:9216
    ds_read_b64_tr_b16 v[116:117], v19 offset:8192
    v_mfma_f32_16x16x32_bf16 v[52:55], v[80:83], v[96:99], v[52:55]
    s_waitcnt lgkmcnt(12)
    v_mfma_f32_16x16x32_bf16 v[56:59], v[84:87], v[92:95], v[56:59]
    ds_read_b64_tr_b16 v[118:119], v19 offset:9216
    ds_read_b64_tr_b16 v[120:121], v20 offset:8192
    v_mfma_f32_16x16x32_bf16 v[60:63], v[84:87], v[96:99], v[60:63]
    s_waitcnt lgkmcnt(11)
    v_mfma_f32_16x16x32_bf16 v[64:67], v[88:91], v[100:103], v[64:67]
    ds_read_b64_tr_b16 v[122:123], v20 offset:9216
    ds_read_b128 v[132:135], v25
    s_add_u32 m0, s58, 104448
    s_add_u32 s57, s15, 36864
    buffer_load_dwordx4 v6, s[20:23], s57 offen  lds
    s_waitcnt lgkmcnt(0)
    s_add_u32 m0, s58, 108544
    s_add_u32 s57, s15, 73728
    buffer_load_dwordx4 v6, s[20:23], s57 offen  lds
    s_add_u32 m0, s58, 112640
    s_add_u32 s57, s15, 110592
    buffer_load_dwordx4 v6, s[20:23], s57 offen  lds
    s_add_u32 m0, s54, 100352
    s_add_u32 s57, s59, s15
    buffer_load_dwordx4 v6, s[20:23], s57 offen  lds
    s_add_u32 s3, s3, 1
    s_cmp_eq_u32 s3, 9
    s_cselect_b32 s3, 0, s3
    s_waitcnt vmcnt(9)
    s_barrier
    v_add_u32 v16, 49152, v8
    v_add_u32 v17, 49152, v9
    v_add_u32 v18, 49152, v10
    v_add_u32 v19, 49152, v11
    v_add_u32 v20, 49152, v12
    v_add_u32 v21, 49152, v13
    v_add_u32 v22, 49152, v14
    v_add_u32 v23, 49152, v15
    v_add_u32 v25, 49152, v24
    v_mfma_f32_16x16x32_bf16 v[32:35], v[104:107], v[124:127], v[32:35]
    ds_read_b128 v[92:95], v21
    ds_read_b128 v[96:99], v21 offset:2048
    ds_read_b64_tr_b16 v[72:73], v16 offset:0
    v_mfma_f32_16x16x32_bf16 v[36:39], v[104:107], v[128:131], v[36:39]
    ds_read_b64_tr_b16 v[74:75], v16 offset:1024
    ds_read_b64_tr_b16 v[76:77], v17 offset:0
    ds_read_b64_tr_b16 v[78:79], v17 offset:1024
    v_mfma_f32_16x16x32_bf16 v[40:43], v[108:111], v[124:127], v[40:43]
    ds_read_b64_tr_b16 v[80:81], v18 offset:0
    ds_read_b64_tr_b16 v[82:83], v18 offset:1024
    ds_read_b64_tr_b16 v[84:85], v19 offset:0
    v_mfma_f32_16x16x32_bf16 v[44:47], v[108:111], v[128:131], v[44:47]
    ds_read_b64_tr_b16 v[86:87], v19 offset:1024
    ds_read_b64_tr_b16 v[88:89], v20 offset:0
    ds_read_b64_tr_b16 v[90:91], v20 offset:1024
    v_mfma_f32_16x16x32_bf16 v[48:51], v[112:115], v[124:127], v[48:51]
    ds_read_b128 v[100:103], v23
    s_lshl_b32 s14, s3, 19
    s_lshl_b32 s15, s3, 7
    s_add_u32 m0, s46, 118784
    s_nop 0
    buffer_load_dwordx4 v2, s[32:35], s14 offen nt lds
    v_mfma_f32_16x16x32_bf16 v[52:55], v[112:115], v[128:131], v[52:55]
    s_add_u32 m0, s46, 119808
    s_nop 0
    buffer_load_dwordx4 v3, s[32:35], s14 offen nt lds
    v_mfma_f32_16x16x32_bf16 v[56:59], v[116:119], v[124:127], v[56:59]
    s_add_u32 m0, s46, 120832
    s_nop 0
    buffer_load_dwordx4 v4, s[32:35], s14 offen nt lds
    v_mfma_f32_16x16x32_bf16 v[60:63], v[116:119], v[128:131], v[60:63]
    s_add_u32 m0, s46, 121856
    s_nop 0
    buffer_load_dwordx4 v5, s[32:35], s14 offen nt lds
    v_mfma_f32_16x16x32_bf16 v[64:67], v[120:123], v[132:135], v[64:67]
    s_add_u32 m0, s58, 135168
    s_add_u32 s57, s15, 0
    buffer_load_dwordx4 v6, s[20:23], s57 offen  lds
    s_waitcnt lgkmcnt(9)
    v_mfma_f32_16x16x32_bf16 v[32:35], v[72:75], v[92:95], v[32:35]
    ds_read_b128 v[124:127], v22
    ds_read_b128 v[128:131], v22 offset:2048
    ds_read_b64_tr_b16 v[104:105], v16 offset:8192
    v_mfma_f32_16x16x32_bf16 v[36:39], v[72:75], v[96:99], v[36:39]
    ds_read_b64_tr_b16 v[106:107], v16 offset:9216
    ds_read_b64_tr_b16 v[108:109], v17 offset:8192
    s_waitcnt lgkmcnt(12)
    v_mfma_f32_16x16x32_bf16 v[40:43], v[76:79], v[92:95], v[40:43]
    ds_read_b64_tr_b16 v[110:111], v17 offset:9216
    ds_read_b64_tr_b16 v[112:113], v18 offset:8192
    v_mfma_f32_16x16x32_bf16 v[44:47], v[76:79], v[96:99], v[44:47]
    s_waitcnt lgkmcnt(12)
    v_mfma_f32_16x16x32_bf16 v[48:51], v[80:83], v[92:95], v[48:51]
    ds_read_b64_tr_b16 v[114:115], v18 offset:9216
    ds_read_b64_tr_b16 v[116:117], v19 offset:8192
    v_mfma_f32_16x16x32_bf16 v[52:55], v[80:83], v[96:99], v[52:55]
    s_waitcnt lgkmcnt(12)
    v_mfma_f32_16x16x32_bf16 v[56:59], v[84:87], v[92:95], v[56:59]
    ds_read_b64_tr_b16 v[118:119], v19 offset:9216
    ds_read_b64_tr_b16 v[120:121], v20 offset:8192
    v_mfma_f32_16x16x32_bf16 v[60:63], v[84:87], v[96:99], v[60:63]
    s_waitcnt lgkmcnt(11)
    v_mfma_f32_16x16x32_bf16 v[64:67], v[88:91], v[100:103], v[64:67]
    ds_read_b64_tr_b16 v[122:123], v20 offset:9216
    ds_read_b128 v[132:135], v25
    s_add_u32 m0, s58, 139264
    s_add_u32 s57, s15, 36864
    buffer_load_dwordx4 v6, s[20:23], s57 offen  lds
    s_waitcnt lgkmcnt(0)
    s_add_u32 m0, s58, 143360
    s_add_u32 s57, s15, 73728
    buffer_load_dwordx4 v6, s[20:23], s57 offen  lds
    s_add_u32 m0, s58, 147456
    s_add_u32 s57, s15, 110592
    buffer_load_dwordx4 v6, s[20:23], s57 offen  lds
    s_add_u32 m0, s54, 135168
    s_add_u32 s57, s59, s15
    buffer_load_dwordx4 v6, s[20:23], s57 offen  lds
    s_add_u32 s3, s3, 1
    s_cmp_eq_u32 s3, 9
    s_cselect_b32 s3, 0, s3
    s_waitcnt vmcnt(9)
    s_barrier
    v_add_u32 v16, 83968, v8
    v_add_u32 v17, 83968, v9
    v_add_u32 v18, 83968, v10
    v_add_u32 v19, 83968, v11
    v_add_u32 v20, 83968, v12
    v_add_u32 v21, 83968, v13
    v_add_u32 v22, 83968, v14
    v_add_u32 v23, 83968, v15
    v_add_u32 v25, 83968, v24
    v_mfma_f32_16x16x32_bf16 v[32:35], v[104:107], v[124:127], v[32:35]
    ds_read_b128 v[92:95], v21
    ds_read_b128 v[96:99], v21 offset:2048
    ds_read_b64_tr_b16 v[72:73], v16 offset:0
    v_mfma_f32_16x16x32_bf16 v[36:39], v[104:107], v[128:131], v[36:39]
    ds_read_b64_tr_b16 v[74:75], v16 offset:1024
    ds_read_b64_tr_b16 v[76:77], v17 offset:0
    ds_read_b64_tr_b16 v[78:79], v17 offset:1024
    v_mfma_f32_16x16x32_bf16 v[40:43], v[108:111], v[124:127], v[40:43]
    ds_read_b64_tr_b16 v[80:81], v18 offset:0
    ds_read_b64_tr_b16 v[82:83], v18 offset:1024
    ds_read_b64_tr_b16 v[84:85], v19 offset:0
    v_mfma_f32_16x16x32_bf16 v[44:47], v[108:111], v[128:131], v[44:47]
    ds_read_b64_tr_b16 v[86:87], v19 offset:1024
    ds_read_b64_tr_b16 v[88:89], v20 offset:0
    ds_read_b64_tr_b16 v[90:91], v20 offset:1024
    v_mfma_f32_16x16x32_bf16 v[48:51], v[112:115], v[124:127], v[48:51]
    ds_read_b128 v[100:103], v23
    s_lshl_b32 s14, s3, 19
    s_lshl_b32 s15, s3, 7
    s_add_u32 m0, s46, 49152
    s_nop 0
    buffer_load_dwordx4 v2, s[32:35], s14 offen nt lds
    v_mfma_f32_16x16x32_bf16 v[52:55], v[112:115], v[128:131], v[52:55]
    s_add_u32 m0, s46, 50176
    s_nop 0
    buffer_load_dwordx4 v3, s[32:35], s14 offen nt lds
    v_mfma_f32_16x16x32_bf16 v[56:59], v[116:119], v[124:127], v[56:59]
    s_add_u32 m0, s46, 51200
    s_nop 0
    buffer_load_dwordx4 v4, s[32:35], s14 offen nt lds
    v_mfma_f32_16x16x32_bf16 v[60:63], v[116:119], v[128:131], v[60:63]
    s_add_u32 m0, s46, 52224
    s_nop 0
    buffer_load_dwordx4 v5, s[32:35], s14 offen nt lds
    v_mfma_f32_16x16x32_bf16 v[64:67], v[120:123], v[132:135], v[64:67]
    s_add_u32 m0, s58, 65536
    s_add_u32 s57, s15, 0
    buffer_load_dwordx4 v6, s[20:23], s57 offen  lds
    s_waitcnt lgkmcnt(9)
    v_mfma_f32_16x16x32_bf16 v[32:35], v[72:75], v[92:95], v[32:35]
    ds_read_b128 v[124:127], v22
    ds_read_b128 v[128:131], v22 offset:2048
    ds_read_b64_tr_b16 v[104:105], v16 offset:8192
    v_mfma_f32_16x16x32_bf16 v[36:39], v[72:75], v[96:99], v[36:39]
    ds_read_b64_tr_b16 v[106:107], v16 offset:9216
    ds_read_b64_tr_b16 v[108:109], v17 offset:8192
    s_waitcnt lgkmcnt(12)
    v_mfma_f32_16x16x32_bf16 v[40:43], v[76:79], v[92:95], v[40:43]
    ds_read_b64_tr_b16 v[110:111], v17 offset:9216
    ds_read_b64_tr_b16 v[112:113], v18 offset:8192
    v_mfma_f32_16x16x32_bf16 v[44:47], v[76:79], v[96:99], v[44:47]
    s_waitcnt lgkmcnt(12)
    v_mfma_f32_16x16x32_bf16 v[48:51], v[80:83], v[92:95], v[48:51]
    ds_read_b64_tr_b16 v[114:115], v18 offset:9216
    ds_read_b64_tr_b16 v[116:117], v19 offset:8192
    v_mfma_f32_16x16x32_bf16 v[52:55], v[80:83], v[96:99], v[52:55]
    s_waitcnt lgkmcnt(12)
    v_mfma_f32_16x16x32_bf16 v[56:59], v[84:87], v[92:95], v[56:59]
    ds_read_b64_tr_b16 v[118:119], v19 offset:9216
    ds_read_b64_tr_b16 v[120:121], v20 offset:8192
    v_mfma_f32_16x16x32_bf16 v[60:63], v[84:87], v[96:99], v[60:63]
    s_waitcnt lgkmcnt(11)
    v_mfma_f32_16x16x32_bf16 v[64:67], v[88:91], v[100:103], v[64:67]
    ds_read_b64_tr_b16 v[122:123], v20 offset:9216
    ds_read_b128 v[132:135], v25
    s_add_u32 m0, s58, 69632
    s_add_u32 s57, s15, 36864
    buffer_load_dwordx4 v6, s[20:23], s57 offen  lds
    s_waitcnt lgkmcnt(0)
    s_add_u32 m0, s58, 73728
    s_add_u32 s57, s15, 73728
    buffer_load_dwordx4 v6, s[20:23], s57 offen  lds
    s_add_u32 m0, s58, 77824
    s_add_u32 s57, s15, 110592
    buffer_load_dwordx4 v6, s[20:23], s57 offen  lds
    s_add_u32 m0, s54, 65536
    s_add_u32 s57, s59, s15
    buffer_load_dwordx4 v6, s[20:23], s57 offen  lds
    s_add_u32 s3, s3, 1
    s_cmp_eq_u32 s3, 9
    s_cselect_b32 s3, 0, s3
    s_waitcnt vmcnt(9)
    s_barrier
    v_add_u32 v16, 118784, v8
    v_add_u32 v17, 118784, v9
    v_add_u32 v18, 118784, v10
    v_add_u32 v19, 118784, v11
    v_add_u32 v20, 118784, v12
    v_add_u32 v21, 118784, v13
    v_add_u32 v22, 118784, v14
    v_add_u32 v23, 118784, v15
    v_add_u32 v25, 118784, v24
    v_mfma_f32_16x16x32_bf16 v[32:35], v[104:107], v[124:127], v[32:35]
    ds_read_b128 v[92:95], v21
    ds_read_b128 v[96:99], v21 offset:2048
    ds_read_b64_tr_b16 v[72:73], v16 offset:0
    v_mfma_f32_16x16x32_bf16 v[36:39], v[104:107], v[128:131], v[36:39]
    ds_read_b64_tr_b16 v[74:75], v16 offset:1024
    ds_read_b64_tr_b16 v[76:77], v17 offset:0
    ds_read_b64_tr_b16 v[78:79], v17 offset:1024
    v_mfma_f32_16x16x32_bf16 v[40:43], v[108:111], v[124:127], v[40:43]
    ds_read_b64_tr_b16 v[80:81], v18 offset:0
    ds_read_b64_tr_b16 v[82:83], v18 offset:1024
    ds_read_b64_tr_b16 v[84:85], v19 offset:0
    v_mfma_f32_16x16x32_bf16 v[44:47], v[108:111], v[128:131], v[44:47]
    ds_read_b64_tr_b16 v[86:87], v19 offset:1024
    ds_read_b64_tr_b16 v[88:89], v20 offset:0
    ds_read_b64_tr_b16 v[90:91], v20 offset:1024
    v_mfma_f32_16x16x32_bf16 v[48:51], v[112:115], v[124:127], v[48:51]
    ds_read_b128 v[100:103], v23
    s_lshl_b32 s14, s3, 19
    s_lshl_b32 s15, s3, 7
    s_add_u32 m0, s46, 83968
    s_nop 0
    buffer_load_dwordx4 v2, s[32:35], s14 offen nt lds
    v_mfma_f32_16x16x32_bf16 v[52:55], v[112:115], v[128:131], v[52:55]
    s_add_u32 m0, s46, 84992
    s_nop 0
    buffer_load_dwordx4 v3, s[32:35], s14 offen nt lds
    v_mfma_f32_16x16x32_bf16 v[56:59], v[116:119], v[124:127], v[56:59]
    s_add_u32 m0, s46, 86016
    s_nop 0
    buffer_load_dwordx4 v4, s[32:35], s14 offen nt lds
    v_mfma_f32_16x16x32_bf16 v[60:63], v[116:119], v[128:131], v[60:63]
    s_add_u32 m0, s46, 87040
    s_nop 0
    buffer_load_dwordx4 v5, s[32:35], s14 offen nt lds
    v_mfma_f32_16x16x32_bf16 v[64:67], v[120:123], v[132:135], v[64:67]
    s_add_u32 m0, s58, 100352
    s_add_u32 s57, s15, 0
    buffer_load_dwordx4 v6, s[20:23], s57 offen  lds
    s_waitcnt lgkmcnt(9)
    v_mfma_f32_16x16x32_bf16 v[32:35], v[72:75], v[92:95], v[32:35]
    ds_read_b128 v[124:127], v22
    ds_read_b128 v[128:131], v22 offset:2048
    ds_read_b64_tr_b16 v[104:105], v16 offset:8192
    v_mfma_f32_16x16x32_bf16 v[36:39], v[72:75], v[96:99], v[36:39]
    ds_read_b64_tr_b16 v[106:107], v16 offset:9216
    ds_read_b64_tr_b16 v[108:109], v17 offset:8192
    s_waitcnt lgkmcnt(12)
    v_mfma_f32_16x16x32_bf16 v[40:43], v[76:79], v[92:95], v[40:43]
    ds_read_b64_tr_b16 v[110:111], v17 offset:9216
    ds_read_b64_tr_b16 v[112:113], v18 offset:8192
    v_mfma_f32_16x16x32_bf16 v[44:47], v[76:79], v[96:99], v[44:47]
    s_waitcnt lgkmcnt(12)
    v_mfma_f32_16x16x32_bf16 v[48:51], v[80:83], v[92:95], v[48:51]
    ds_read_b64_tr_b16 v[114:115], v18 offset:9216
    ds_read_b64_tr_b16 v[116:117], v19 offset:8192
    v_mfma_f32_16x16x32_bf16 v[52:55], v[80:83], v[96:99], v[52:55]
    s_waitcnt lgkmcnt(12)
    v_mfma_f32_16x16x32_bf16 v[56:59], v[84:87], v[92:95], v[56:59]
    ds_read_b64_tr_b16 v[118:119], v19 offset:9216
    ds_read_b64_tr_b16 v[120:121], v20 offset:8192
    v_mfma_f32_16x16x32_bf16 v[60:63], v[84:87], v[96:99], v[60:63]
    s_waitcnt lgkmcnt(11)
    v_mfma_f32_16x16x32_bf16 v[64:67], v[88:91], v[100:103], v[64:67]
    ds_read_b64_tr_b16 v[122:123], v20 offset:9216
    ds_read_b128 v[132:135], v25
    s_add_u32 m0, s58, 104448
    s_add_u32 s57, s15, 36864
    buffer_load_dwordx4 v6, s[20:23], s57 offen  lds
    s_waitcnt lgkmcnt(0)
    s_add_u32 m0, s58, 108544
    s_add_u32 s57, s15, 73728
    buffer_load_dwordx4 v6, s[20:23], s57 offen  lds
    s_add_u32 m0, s58, 112640
    s_add_u32 s57, s15, 110592
    buffer_load_dwordx4 v6, s[20:23], s57 offen  lds
    s_add_u32 m0, s54, 100352
    s_add_u32 s57, s59, s15
    buffer_load_dwordx4 v6, s[20:23], s57 offen  lds
    s_add_u32 s3, s3, 1
    s_cmp_eq_u32 s3, 9
    s_cselect_b32 s3, 0, s3
    s_waitcnt vmcnt(9)
    s_barrier
    v_add_u32 v16, 49152, v8
    v_add_u32 v17, 49152, v9
    v_add_u32 v18, 49152, v10
    v_add_u32 v19, 49152, v11
    v_add_u32 v20, 49152, v12
    v_add_u32 v21, 49152, v13
    v_add_u32 v22, 49152, v14
    v_add_u32 v23, 49152, v15
    v_add_u32 v25, 49152, v24
    v_mfma_f32_16x16x32_bf16 v[32:35], v[104:107], v[124:127], v[32:35]
    ds_read_b128 v[92:95], v21
    ds_read_b128 v[96:99], v21 offset:2048
    ds_read_b64_tr_b16 v[72:73], v16 offset:0
    v_mfma_f32_16x16x32_bf16 v[36:39], v[104:107], v[128:131], v[36:39]
    ds_read_b64_tr_b16 v[74:75], v16 offset:1024
    ds_read_b64_tr_b16 v[76:77], v17 offset:0
    ds_read_b64_tr_b16 v[78:79], v17 offset:1024
    v_mfma_f32_16x16x32_bf16 v[40:43], v[108:111], v[124:127], v[40:43]
    ds_read_b64_tr_b16 v[80:81], v18 offset:0
    ds_read_b64_tr_b16 v[82:83], v18 offset:1024
    ds_read_b64_tr_b16 v[84:85], v19 offset:0
    v_mfma_f32_16x16x32_bf16 v[44:47], v[108:111], v[128:131], v[44:47]
    ds_read_b64_tr_b16 v[86:87], v19 offset:1024
    ds_read_b64_tr_b16 v[88:89], v20 offset:0
    ds_read_b64_tr_b16 v[90:91], v20 offset:1024
    v_mfma_f32_16x16x32_bf16 v[48:51], v[112:115], v[124:127], v[48:51]
    ds_read_b128 v[100:103], v23
    s_lshl_b32 s14, s3, 19
    s_lshl_b32 s15, s3, 7
    s_add_u32 m0, s46, 118784
    s_nop 0
    buffer_load_dwordx4 v2, s[32:35], s14 offen nt lds
    v_mfma_f32_16x16x32_bf16 v[52:55], v[112:115], v[128:131], v[52:55]
    s_add_u32 m0, s46, 119808
    s_nop 0
    buffer_load_dwordx4 v3, s[32:35], s14 offen nt lds
    v_mfma_f32_16x16x32_bf16 v[56:59], v[116:119], v[124:127], v[56:59]
    s_add_u32 m0, s46, 120832
    s_nop 0
    buffer_load_dwordx4 v4, s[32:35], s14 offen nt lds
    v_mfma_f32_16x16x32_bf16 v[60:63], v[116:119], v[128:131], v[60:63]
    s_add_u32 m0, s46, 121856
    s_nop 0
    buffer_load_dwordx4 v5, s[32:35], s14 offen nt lds
    v_mfma_f32_16x16x32_bf16 v[64:67], v[120:123], v[132:135], v[64:67]
    s_add_u32 m0, s58, 135168
    s_add_u32 s57, s15, 0
    buffer_load_dwordx4 v6, s[20:23], s57 offen  lds
    s_waitcnt lgkmcnt(9)
    v_mfma_f32_16x16x32_bf16 v[32:35], v[72:75], v[92:95], v[32:35]
    ds_read_b128 v[124:127], v22
    ds_read_b128 v[128:131], v22 offset:2048
    ds_read_b64_tr_b16 v[104:105], v16 offset:8192
    v_mfma_f32_16x16x32_bf16 v[36:39], v[72:75], v[96:99], v[36:39]
    ds_read_b64_tr_b16 v[106:107], v16 offset:9216
    ds_read_b64_tr_b16 v[108:109], v17 offset:8192
    s_waitcnt lgkmcnt(12)
    v_mfma_f32_16x16x32_bf16 v[40:43], v[76:79], v[92:95], v[40:43]
    ds_read_b64_tr_b16 v[110:111], v17 offset:9216
    ds_read_b64_tr_b16 v[112:113], v18 offset:8192
    v_mfma_f32_16x16x32_bf16 v[44:47], v[76:79], v[96:99], v[44:47]
    s_waitcnt lgkmcnt(12)
    v_mfma_f32_16x16x32_bf16 v[48:51], v[80:83], v[92:95], v[48:51]
    ds_read_b64_tr_b16 v[114:115], v18 offset:9216
    ds_read_b64_tr_b16 v[116:117], v19 offset:8192
    v_mfma_f32_16x16x32_bf16 v[52:55], v[80:83], v[96:99], v[52:55]
    s_waitcnt lgkmcnt(12)
    v_mfma_f32_16x16x32_bf16 v[56:59], v[84:87], v[92:95], v[56:59]
    ds_read_b64_tr_b16 v[118:119], v19 offset:9216
    ds_read_b64_tr_b16 v[120:121], v20 offset:8192
    v_mfma_f32_16x16x32_bf16 v[60:63], v[84:87], v[96:99], v[60:63]
    s_waitcnt lgkmcnt(11)
    v_mfma_f32_16x16x32_bf16 v[64:67], v[88:91], v[100:103], v[64:67]
    ds_read_b64_tr_b16 v[122:123], v20 offset:9216
    ds_read_b128 v[132:135], v25
    s_add_u32 m0, s58, 139264
    s_add_u32 s57, s15, 36864
    buffer_load_dwordx4 v6, s[20:23], s57 offen  lds
    s_waitcnt lgkmcnt(0)
    s_add_u32 m0, s58, 143360
    s_add_u32 s57, s15, 73728
    buffer_load_dwordx4 v6, s[20:23], s57 offen  lds
    s_add_u32 m0, s58, 147456
    s_add_u32 s57, s15, 110592
    buffer_load_dwordx4 v6, s[20:23], s57 offen  lds
    s_add_u32 m0, s54, 135168
    s_add_u32 s57, s59, s15
    buffer_load_dwordx4 v6, s[20:23], s57 offen  lds
    s_add_u32 s3, s3, 1
    s_cmp_eq_u32 s3, 9
    s_cselect_b32 s3, 0, s3
    s_waitcnt vmcnt(9)
    s_barrier
    v_add_u32 v16, 83968, v8
    v_add_u32 v17, 83968, v9
    v_add_u32 v18, 83968, v10
    v_add_u32 v19, 83968, v11
    v_add_u32 v20, 83968, v12
    v_add_u32 v21, 83968, v13
    v_add_u32 v22, 83968, v14
    v_add_u32 v23, 83968, v15
    v_add_u32 v25, 83968, v24
    v_mfma_f32_16x16x32_bf16 v[32:35], v[104:107], v[124:127], v[32:35]
    ds_read_b128 v[92:95], v21
    ds_read_b128 v[96:99], v21 offset:2048
    ds_read_b64_tr_b16 v[72:73], v16 offset:0
    v_mfma_f32_16x16x32_bf16 v[36:39], v[104:107], v[128:131], v[36:39]
    ds_read_b64_tr_b16 v[74:75], v16 offset:1024
    ds_read_b64_tr_b16 v[76:77], v17 offset:0
    ds_read_b64_tr_b16 v[78:79], v17 offset:1024
    v_mfma_f32_16x16x32_bf16 v[40:43], v[108:111], v[124:127], v[40:43]
    ds_read_b64_tr_b16 v[80:81], v18 offset:0
    ds_read_b64_tr_b16 v[82:83], v18 offset:1024
    ds_read_b64_tr_b16 v[84:85], v19 offset:0
    v_mfma_f32_16x16x32_bf16 v[44:47], v[108:111], v[128:131], v[44:47]
    ds_read_b64_tr_b16 v[86:87], v19 offset:1024
    ds_read_b64_tr_b16 v[88:89], v20 offset:0
    ds_read_b64_tr_b16 v[90:91], v20 offset:1024
    v_mfma_f32_16x16x32_bf16 v[48:51], v[112:115], v[124:127], v[48:51]
    ds_read_b128 v[100:103], v23
    v_mfma_f32_16x16x32_bf16 v[52:55], v[112:115], v[128:131], v[52:55]
    v_mfma_f32_16x16x32_bf16 v[56:59], v[116:119], v[124:127], v[56:59]
    v_mfma_f32_16x16x32_bf16 v[60:63], v[116:119], v[128:131], v[60:63]
    v_mfma_f32_16x16x32_bf16 v[64:67], v[120:123], v[132:135], v[64:67]
    s_waitcnt lgkmcnt(9)
    v_mfma_f32_16x16x32_bf16 v[32:35], v[72:75], v[92:95], v[32:35]
    ds_read_b128 v[124:127], v22
    ds_read_b128 v[128:131], v22 offset:2048
    ds_read_b64_tr_b16 v[104:105], v16 offset:8192
    v_mfma_f32_16x16x32_bf16 v[36:39], v[72:75], v[96:99], v[36:39]
    ds_read_b64_tr_b16 v[106:107], v16 offset:9216
    ds_read_b64_tr_b16 v[108:109], v17 offset:8192
    s_waitcnt lgkmcnt(12)
    v_mfma_f32_16x16x32_bf16 v[40:43], v[76:79], v[92:95], v[40:43]
    ds_read_b64_tr_b16 v[110:111], v17 offset:9216
    ds_read_b64_tr_b16 v[112:113], v18 offset:8192
    v_mfma_f32_16x16x32_bf16 v[44:47], v[76:79], v[96:99], v[44:47]
    s_waitcnt lgkmcnt(12)
    v_mfma_f32_16x16x32_bf16 v[48:51], v[80:83], v[92:95], v[48:51]
    ds_read_b64_tr_b16 v[114:115], v18 offset:9216
    ds_read_b64_tr_b16 v[116:117], v19 offset:8192
    v_mfma_f32_16x16x32_bf16 v[52:55], v[80:83], v[96:99], v[52:55]
    s_waitcnt lgkmcnt(12)
    v_mfma_f32_16x16x32_bf16 v[56:59], v[84:87], v[92:95], v[56:59]
    ds_read_b64_tr_b16 v[118:119], v19 offset:9216
    ds_read_b64_tr_b16 v[120:121], v20 offset:8192
    v_mfma_f32_16x16x32_bf16 v[60:63], v[84:87], v[96:99], v[60:63]
    s_waitcnt lgkmcnt(11)
    v_mfma_f32_16x16x32_bf16 v[64:67], v[88:91], v[100:103], v[64:67]
    ds_read_b64_tr_b16 v[122:123], v20 offset:9216
    ds_read_b128 v[132:135], v25
    s_waitcnt lgkmcnt(0)
    s_waitcnt vmcnt(0)
    s_barrier
    v_add_u32 v16, 118784, v8
    v_add_u32 v17, 118784, v9
    v_add_u32 v18, 118784, v10
    v_add_u32 v19, 118784, v11
    v_add_u32 v20, 118784, v12
    v_add_u32 v21, 118784, v13
    v_add_u32 v22, 118784, v14
    v_add_u32 v23, 118784, v15
    v_add_u32 v25, 118784, v24
    v_mfma_f32_16x16x32_bf16 v[32:35], v[104:107], v[124:127], v[32:35]
    ds_read_b128 v[92:95], v21
    ds_read_b128 v[96:99], v21 offset:2048
    ds_read_b64_tr_b16 v[72:73], v16 offset:0
    v_mfma_f32_16x16x32_bf16 v[36:39], v[104:107], v[128:131], v[36:39]
    ds_read_b64_tr_b16 v[74:75], v16 offset:1024
    ds_read_b64_tr_b16 v[76:77], v17 offset:0
    ds_read_b64_tr_b16 v[78:79], v17 offset:1024
    v_mfma_f32_16x16x32_bf16 v[40:43], v[108:111], v[124:127], v[40:43]
    ds_read_b64_tr_b16 v[80:81], v18 offset:0
    ds_read_b64_tr_b16 v[82:83], v18 offset:1024
    ds_read_b64_tr_b16 v[84:85], v19 offset:0
    v_mfma_f32_16x16x32_bf16 v[44:47], v[108:111], v[128:131], v[44:47]
    ds_read_b64_tr_b16 v[86:87], v19 offset:1024
    ds_read_b64_tr_b16 v[88:89], v20 offset:0
    ds_read_b64_tr_b16 v[90:91], v20 offset:1024
    v_mfma_f32_16x16x32_bf16 v[48:51], v[112:115], v[124:127], v[48:51]
    ds_read_b128 v[100:103], v23
    v_mfma_f32_16x16x32_bf16 v[52:55], v[112:115], v[128:131], v[52:55]
    v_mfma_f32_16x16x32_bf16 v[56:59], v[116:119], v[124:127], v[56:59]
    v_mfma_f32_16x16x32_bf16 v[60:63], v[116:119], v[128:131], v[60:63]
    v_mfma_f32_16x16x32_bf16 v[64:67], v[120:123], v[132:135], v[64:67]
    s_waitcnt lgkmcnt(9)
    v_mfma_f32_16x16x32_bf16 v[32:35], v[72:75], v[92:95], v[32:35]
    ds_read_b128 v[124:127], v22
    ds_read_b128 v[128:131], v22 offset:2048
    ds_read_b64_tr_b16 v[104:105], v16 offset:8192
    v_mfma_f32_16x16x32_bf16 v[36:39], v[72:75], v[96:99], v[36:39]
    ds_read_b64_tr_b16 v[106:107], v16 offset:9216
    ds_read_b64_tr_b16 v[108:109], v17 offset:8192
    s_waitcnt lgkmcnt(12)
    v_mfma_f32_16x16x32_bf16 v[40:43], v[76:79], v[92:95], v[40:43]
    ds_read_b64_tr_b16 v[110:111], v17 offset:9216
    ds_read_b64_tr_b16 v[112:113], v18 offset:8192
    v_mfma_f32_16x16x32_bf16 v[44:47], v[76:79], v[96:99], v[44:47]
    s_waitcnt lgkmcnt(12)
    v_mfma_f32_16x16x32_bf16 v[48:51], v[80:83], v[92:95], v[48:51]
    ds_read_b64_tr_b16 v[114:115], v18 offset:9216
    ds_read_b64_tr_b16 v[116:117], v19 offset:8192
    v_mfma_f32_16x16x32_bf16 v[52:55], v[80:83], v[96:99], v[52:55]
    s_waitcnt lgkmcnt(12)
    v_mfma_f32_16x16x32_bf16 v[56:59], v[84:87], v[92:95], v[56:59]
    ds_read_b64_tr_b16 v[118:119], v19 offset:9216
    ds_read_b64_tr_b16 v[120:121], v20 offset:8192
    v_mfma_f32_16x16x32_bf16 v[60:63], v[84:87], v[96:99], v[60:63]
    s_waitcnt lgkmcnt(11)
    v_mfma_f32_16x16x32_bf16 v[64:67], v[88:91], v[100:103], v[64:67]
    ds_read_b64_tr_b16 v[122:123], v20 offset:9216
    ds_read_b128 v[132:135], v25
    s_waitcnt lgkmcnt(9)
    v_mfma_f32_16x16x32_bf16 v[32:35], v[104:107], v[124:127], v[32:35]
    v_mfma_f32_16x16x32_bf16 v[36:39], v[104:107], v[128:131], v[36:39]
    s_waitcnt lgkmcnt(7)
    v_mfma_f32_16x16x32_bf16 v[40:43], v[108:111], v[124:127], v[40:43]
    v_mfma_f32_16x16x32_bf16 v[44:47], v[108:111], v[128:131], v[44:47]
    s_waitcnt lgkmcnt(5)
    v_mfma_f32_16x16x32_bf16 v[48:51], v[112:115], v[124:127], v[48:51]
    v_mfma_f32_16x16x32_bf16 v[52:55], v[112:115], v[128:131], v[52:55]
    s_waitcnt lgkmcnt(3)
    v_mfma_f32_16x16x32_bf16 v[56:59], v[116:119], v[124:127], v[56:59]
    v_mfma_f32_16x16x32_bf16 v[60:63], v[116:119], v[128:131], v[60:63]
    s_waitcnt lgkmcnt(0)
    v_mfma_f32_16x16x32_bf16 v[64:67], v[120:123], v[132:135], v[64:67]
    s_waitcnt lgkmcnt(0)
    s_lshl_b32 s47, s45, 5
    v_add_u32 v1, s47, v27
    v_mul_u32_u24 v1, 272, v1
    v_lshl_add_u32 v12, v28, 4, v1
    v_add_u32 v12, 83968, v12
    v_lshl_add_u32 v1, v28, 3, v1
    v_add_u32 v1, 83968, v1
    v_mul_u32_u24 v8, 272, v27
    v_lshl_add_u32 v13, v28, 4, v8
    v_add_u32 v13, 153600, v13
    v_lshl_add_u32 v8, v28, 3, v8
    s_lshl_b32 s47, s44, 5
    s_add_u32 s47, s47, 153600
    v_add_u32 v8, s47, v8
    v_cvt_pk_bf16_f32 v72, v32, v33
    v_cvt_pk_bf16_f32 v73, v34, v35
    ds_write_b64 v1, v[72:73] offset:0
    v_cvt_pk_bf16_f32 v74, v36, v37
    v_cvt_pk_bf16_f32 v75, v38, v39
    ds_write_b64 v1, v[74:75] offset:4352
    v_cvt_pk_bf16_f32 v76, v40, v41
    v_cvt_pk_bf16_f32 v77, v42, v43
    ds_write_b64 v1, v[76:77] offset:32
    v_cvt_pk_bf16_f32 v78, v44, v45
    v_cvt_pk_bf16_f32 v79, v46, v47
    ds_write_b64 v1, v[78:79] offset:4384
    v_cvt_pk_bf16_f32 v80, v48, v49
    v_cvt_pk_bf16_f32 v81, v50, v51
    ds_write_b64 v1, v[80:81] offset:64
    v_cvt_pk_bf16_f32 v82, v52, v53
    v_cvt_pk_bf16_f32 v83, v54, v55
    ds_write_b64 v1, v[82:83] offset:4416
    v_cvt_pk_bf16_f32 v84, v56, v57
    v_cvt_pk_bf16_f32 v85, v58, v59
    ds_write_b64 v1, v[84:85] offset:96
    v_cvt_pk_bf16_f32 v86, v60, v61
    v_cvt_pk_bf16_f32 v87, v62, v63
    ds_write_b64 v1, v[86:87] offset:4448
    v_cvt_pk_bf16_f32 v88, v64, v65
    v_cvt_pk_bf16_f32 v89, v66, v67
    ds_write_b64 v8, v[88:89]
    s_waitcnt lgkmcnt(0)
    s_barrier
    ds_read_b128 v[32:35], v12 offset:0
    ds_read_b128 v[36:39], v12 offset:64
    ds_read_b128 v[40:43], v12 offset:128
    ds_read_b128 v[44:47], v12 offset:192
    ds_read_b128 v[48:51], v12 offset:4352
    ds_read_b128 v[52:55], v12 offset:4416
    ds_read_b128 v[56:59], v12 offset:4480
    ds_read_b128 v[60:63], v12 offset:4544
    ds_read_b128 v[64:67], v13 offset:0
    ds_read_b128 v[68:71], v13 offset:64
    ds_read_b128 v[72:75], v13 offset:128
    ds_read_b128 v[76:79], v13 offset:192
    v_lshlrev_b32 v1, 8, v27
    v_add_u32 v8, 0, v28
    v_xor_b32 v8, v8, v27
    v_lshl_add_u32 v8, v8, 4, v1
    v_add_u32 v9, 4, v28
    v_xor_b32 v9, v9, v27
    v_lshl_add_u32 v9, v9, 4, v1
    v_add_u32 v10, 8, v28
    v_xor_b32 v10, v10, v27
    v_lshl_add_u32 v10, v10, 4, v1
    v_add_u32 v11, 12, v28
    v_xor_b32 v11, v11, v27
    v_lshl_add_u32 v11, v11, 4, v1
    s_waitcnt lgkmcnt(0)
    s_barrier
    v_add_u32 v16, 0, v8
    v_add_u32 v17, 0, v9
    v_add_u32 v18, 0, v10
    v_add_u32 v19, 0, v11
    ds_read_b128 v[224:227], v16 offset:0
    ds_read_b128 v[228:231], v17 offset:0
    ds_read_b128 v[232:235], v18 offset:0
    ds_read_b128 v[236:239], v19 offset:0
    s_waitcnt lgkmcnt(3)
    v_mfma_f32_16x16x32_bf16 v[80:83], v[224:227], v[32:35], 0
    ds_read_b128 v[240:243], v16 offset:4096
    v_mfma_f32_16x16x32_bf16 v[84:87], v[224:227], v[48:51], 0
    ds_read_b128 v[244:247], v17 offset:4096
    s_waitcnt lgkmcnt(4)
    v_mfma_f32_16x16x32_bf16 v[80:83], v[228:231], v[36:39], v[80:83]
    ds_read_b128 v[248:251], v18 offset:4096
    v_mfma_f32_16x16x32_bf16 v[84:87], v[228:231], v[52:55], v[84:87]
    ds_read_b128 v[252:255], v19 offset:4096
    s_waitcnt lgkmcnt(5)
    v_mfma_f32_16x16x32_bf16 v[80:83], v[232:235], v[40:43], v[80:83]
    v_mfma_f32_16x16x32_bf16 v[84:87], v[232:235], v[56:59], v[84:87]
    s_waitcnt lgkmcnt(4)
    v_mfma_f32_16x16x32_bf16 v[80:83], v[236:239], v[44:47], v[80:83]
    v_mfma_f32_16x16x32_bf16 v[84:87], v[236:239], v[60:63], v[84:87]
    s_cmp_eq_u32 s45, 0
    s_cbranch_scc0 .L1
    v_mfma_f32_16x16x32_bf16 v[208:211], v[224:227], v[64:67], 0
    v_mfma_f32_16x16x32_bf16 v[208:211], v[228:231], v[68:71], v[208:211]
    v_mfma_f32_16x16x32_bf16 v[208:211], v[232:235], v[72:75], v[208:211]
    v_mfma_f32_16x16x32_bf16 v[208:211], v[236:239], v[76:79], v[208:211]
.L1:
    s_waitcnt lgkmcnt(3)
    v_mfma_f32_16x16x32_bf16 v[88:91], v[240:243], v[32:35], 0
    ds_read_b128 v[224:227], v16 offset:8192
    v_mfma_f32_16x16x32_bf16 v[92:95], v[240:243], v[48:51], 0
    ds_read_b128 v[228:231], v17 offset:8192
    s_waitcnt lgkmcnt(4)
    v_mfma_f32_16x16x32_bf16 v[88:91], v[244:247], v[36:39], v[88:91]
    ds_read_b128 v[232:235], v18 offset:8192
    v_mfma_f32_16x16x32_bf16 v[92:95], v[244:247], v[52:55], v[92:95]
    ds_read_b128 v[236:239], v19 offset:8192
    s_waitcnt lgkmcnt(5)
    v_mfma_f32_16x16x32_bf16 v[88:91], v[248:251], v[40:43], v[88:91]
    v_mfma_f32_16x16x32_bf16 v[92:95], v[248:251], v[56:59], v[92:95]
    s_waitcnt lgkmcnt(4)
    v_mfma_f32_16x16x32_bf16 v[88:91], v[252:255], v[44:47], v[88:91]
    v_mfma_f32_16x16x32_bf16 v[92:95], v[252:255], v[60:63], v[92:95]
    s_cmp_eq_u32 s45, 0
    s_cbranch_scc0 .L2
    v_mfma_f32_16x16x32_bf16 v[212:215], v[240:243], v[64:67], 0
    v_mfma_f32_16x16x32_bf16 v[212:215], v[244:247], v[68:71], v[212:215]
    v_mfma_f32_16x16x32_bf16 v[212:215], v[248:251], v[72:75], v[212:215]
    v_mfma_f32_16x16x32_bf16 v[212:215], v[252:255], v[76:79], v[212:215]
.L2:
    s_waitcnt lgkmcnt(3)
    v_mfma_f32_16x16x32_bf16 v[96:99], v[224:227], v[32:35], 0
    ds_read_b128 v[240:243], v16 offset:12288
    v_max3_f32 v20, v80, v81, v82
    v_mfma_f32_16x16x32_bf16 v[100:103], v[224:227], v[48:51], 0
    ds_read_b128 v[244:247], v17 offset:12288
    v_max_f32 v20, v20, v83
    s_waitcnt lgkmcnt(4)
    v_mfma_f32_16x16x32_bf16 v[96:99], v[228:231], v[36:39], v[96:99]
    ds_read_b128 v[248:251], v18 offset:12288
    v_max3_f32 v21, v84, v85, v86
    v_mfma_f32_16x16x32_bf16 v[100:103], v[228:231], v[52:55], v[100:103]
    ds_read_b128 v[252:255], v19 offset:12288
    v_max_f32 v21, v21, v87
    s_waitcnt lgkmcnt(5)
    v_mfma_f32_16x16x32_bf16 v[96:99], v[232:235], v[40:43], v[96:99]
    v_mfma_f32_16x16x32_bf16 v[100:103], v[232:235], v[56:59], v[100:103]
    s_waitcnt lgkmcnt(4)
    v_mfma_f32_16x16x32_bf16 v[96:99], v[236:239], v[44:47], v[96:99]
    v_mfma_f32_16x16x32_bf16 v[100:103], v[236:239], v[60:63], v[100:103]
    s_cmp_eq_u32 s45, 0
    s_cbranch_scc0 .L3
    v_mfma_f32_16x16x32_bf16 v[216:219], v[224:227], v[64:67], 0
    v_mfma_f32_16x16x32_bf16 v[216:219], v[228:231], v[68:71], v[216:219]
    v_mfma_f32_16x16x32_bf16 v[216:219], v[232:235], v[72:75], v[216:219]
    v_mfma_f32_16x16x32_bf16 v[216:219], v[236:239], v[76:79], v[216:219]
.L3:
    s_waitcnt lgkmcnt(0)
    s_barrier
    v_add_u32 v16, 16384, v8
    v_add_u32 v17, 16384, v9
    v_add_u32 v18, 16384, v10
    v_add_u32 v19, 16384, v11
    v_mfma_f32_16x16x32_bf16 v[104:107], v[240:243], v[32:35], 0
    ds_read_b128 v[224:227], v16 offset:0
    v_max3_f32 v20, v20, v88, v89
    v_mfma_f32_16x16x32_bf16 v[108:111], v[240:243], v[48:51], 0
    ds_read_b128 v[228:231], v17 offset:0
    v_max3_f32 v20, v20, v90, v91
    v_mfma_f32_16x16x32_bf16 v[104:107], v[244:247], v[36:39], v[104:107]
    ds_read_b128 v[232:235], v18 offset:0
    v_max3_f32 v21, v21, v92, v93
    v_mfma_f32_16x16x32_bf16 v[108:111], v[244:247], v[52:55], v[108:111]
    ds_read_b128 v[236:239], v19 offset:0
    v_max3_f32 v21, v21, v94, v95
    v_mfma_f32_16x16x32_bf16 v[104:107], v[248:251], v[40:43], v[104:107]
    v_mfma_f32_16x16x32_bf16 v[108:111], v[248:251], v[56:59], v[108:111]
    v_mfma_f32_16x16x32_bf16 v[104:107], v[252:255], v[44:47], v[104:107]
    v_mfma_f32_16x16x32_bf16 v[108:111], v[252:255], v[60:63], v[108:111]
    s_cmp_eq_u32 s45, 0
    s_cbranch_scc0 .L4
    v_mfma_f32_16x16x32_bf16 v[220:223], v[240:243], v[64:67], 0
    v_mfma_f32_16x16x32_bf16 v[220:223], v[244:247], v[68:71], v[220:223]
    v_mfma_f32_16x16x32_bf16 v[220:223], v[248:251], v[72:75], v[220:223]
    v_mfma_f32_16x16x32_bf16 v[220:223], v[252:255], v[76:79], v[220:223]
.L4:
    s_waitcnt lgkmcnt(3)
    v_mfma_f32_16x16x32_bf16 v[112:115], v[224:227], v[32:35], 0
    ds_read_b128 v[240:243], v16 offset:4096
    v_max3_f32 v20, v20, v96, v97
    v_mfma_f32_16x16x32_bf16 v[116:119], v[224:227], v[48:51], 0
    ds_read_b128 v[244:247], v17 offset:4096
    v_max3_f32 v20, v20, v98, v99
    s_waitcnt lgkmcnt(4)
    v_mfma_f32_16x16x32_bf16 v[112:115], v[228:231], v[36:39], v[112:115]
    ds_read_b128 v[248:251], v18 offset:4096
    v_max3_f32 v21, v21, v100, v101
    v_mfma_f32_16x16x32_bf16 v[116:119], v[228:231], v[52:55], v[116:119]
    ds_read_b128 v[252:255], v19 offset:4096
    v_max3_f32 v21, v21, v102, v103
    s_waitcnt lgkmcnt(5)
    v_mfma_f32_16x16x32_bf16 v[112:115], v[232:235], v[40:43], v[112:115]
    v_mfma_f32_16x16x32_bf16 v[116:119], v[232:235], v[56:59], v[116:119]
    s_waitcnt lgkmcnt(4)
    v_mfma_f32_16x16x32_bf16 v[112:115], v[236:239], v[44:47], v[112:115]
    v_mfma_f32_16x16x32_bf16 v[116:119], v[236:239], v[60:63], v[116:119]
    s_cmp_eq_u32 s45, 1
    s_cbranch_scc0 .L5
    v_mfma_f32_16x16x32_bf16 v[208:211], v[224:227], v[64:67], 0
    v_mfma_f32_16x16x32_bf16 v[208:211], v[228:231], v[68:71], v[208:211]
    v_mfma_f32_16x16x32_bf16 v[208:211], v[232:235], v[72:75], v[208:211]
    v_mfma_f32_16x16x32_bf16 v[208:211], v[236:239], v[76:79], v[208:211]
.L5:
    s_waitcnt lgkmcnt(3)
    v_mfma_f32_16x16x32_bf16 v[120:123], v[240:243], v[32:35], 0
    ds_read_b128 v[224:227], v16 offset:8192
    v_max3_f32 v20, v20, v104, v105
    v_mfma_f32_16x16x32_bf16 v[124:127], v[240:243], v[48:51], 0
    ds_read_b128 v[228:231], v17 offset:8192
    v_max3_f32 v20, v20, v106, v107
    s_waitcnt lgkmcnt(4)
    v_mfma_f32_16x16x32_bf16 v[120:123], v[244:247], v[36:39], v[120:123]
    ds_read_b128 v[232:235], v18 offset:8192
    v_max3_f32 v21, v21, v108, v109
    v_mfma_f32_16x16x32_bf16 v[124:127], v[244:247], v[52:55], v[124:127]
    ds_read_b128 v[236:239], v19 offset:8192
    v_max3_f32 v21, v21, v110, v111
    s_waitcnt lgkmcnt(5)
    v_mfma_f32_16x16x32_bf16 v[120:123], v[248:251], v[40:43], v[120:123]
    v_mfma_f32_16x16x32_bf16 v[124:127], v[248:251], v[56:59], v[124:127]
    s_waitcnt lgkmcnt(4)
    v_mfma_f32_16x16x32_bf16 v[120:123], v[252:255], v[44:47], v[120:123]
    v_mfma_f32_16x16x32_bf16 v[124:127], v[252:255], v[60:63], v[124:127]
    s_cmp_eq_u32 s45, 1
    s_cbranch_scc0 .L6
    v_mfma_f32_16x16x32_bf16 v[212:215], v[240:243], v[64:67], 0
    v_mfma_f32_16x16x32_bf16 v[212:215], v[244:247], v[68:71], v[212:215]
    v_mfma_f32_16x16x32_bf16 v[212:215], v[248:251], v[72:75], v[212:215]
    v_mfma_f32_16x16x32_bf16 v[212:215], v[252:255], v[76:79], v[212:215]
.L6:
    s_waitcnt lgkmcnt(3)
    v_mfma_f32_16x16x32_bf16 v[128:131], v[224:227], v[32:35], 0
    ds_read_b128 v[240:243], v16 offset:12288
    v_max3_f32 v20, v20, v112, v113
    v_mfma_f32_16x16x32_bf16 v[132:135], v[224:227], v[48:51], 0
    ds_read_b128 v[244:247], v17 offset:12288
    v_max3_f32 v20, v20, v114, v115
    s_waitcnt lgkmcnt(4)
    v_mfma_f32_16x16x32_bf16 v[128:131], v[228:231], v[36:39], v[128:131]
    ds_read_b128 v[248:251], v18 offset:12288
    v_max3_f32 v21, v21, v116, v117
    v_mfma_f32_16x16x32_bf16 v[132:135], v[228:231], v[52:55], v[132:135]
    ds_read_b128 v[252:255], v19 offset:12288
    v_max3_f32 v21, v21, v118, v119
    s_waitcnt lgkmcnt(5)
    v_mfma_f32_16x16x32_bf16 v[128:131], v[232:235], v[40:43], v[128:131]
    v_mfma_f32_16x16x32_bf16 v[132:135], v[232:235], v[56:59], v[132:135]
    s_waitcnt lgkmcnt(4)
    v_mfma_f32_16x16x32_bf16 v[128:131], v[236:239], v[44:47], v[128:131]
    v_mfma_f32_16x16x32_bf16 v[132:135], v[236:239], v[60:63], v[132:135]
    s_cmp_eq_u32 s45, 1
    s_cbranch_scc0 .L7
    v_mfma_f32_16x16x32_bf16 v[216:219], v[224:227], v[64:67], 0
    v_mfma_f32_16x16x32_bf16 v[216:219], v[228:231], v[68:71], v[216:219]
    v_mfma_f32_16x16x32_bf16 v[216:219], v[232:235], v[72:75], v[216:219]
    v_mfma_f32_16x16x32_bf16 v[216:219], v[236:239], v[76:79], v[216:219]
.L7:
    s_waitcnt lgkmcnt(0)
    s_barrier
    v_add_u32 v16, 32768, v8
    v_add_u32 v17, 32768, v9
    v_add_u32 v18, 32768, v10
    v_add_u32 v19, 32768, v11
    v_mfma_f32_16x16x32_bf16 v[136:139], v[240:243], v[32:35], 0
    ds_read_b128 v[224:227], v16 offset:0
    v_max3_f32 v20, v20, v120, v121
    v_mfma_f32_16x16x32_bf16 v[140:143], v[240:243], v[48:51], 0
    ds_read_b128 v[228:231], v17 offset:0
    v_max3_f32 v20, v20, v122, v123
    v_mfma_f32_16x16x32_bf16 v[136:139], v[244:247], v[36:39], v[136:139]
    ds_read_b128 v[232:235], v18 offset:0
    v_max3_f32 v21, v21, v124, v125
    v_mfma_f32_16x16x32_bf16 v[140:143], v[244:247], v[52:55], v[140:143]
    ds_read_b128 v[236:239], v19 offset:0
    v_max3_f32 v21, v21, v126, v127
    v_mfma_f32_16x16x32_bf16 v[136:139], v[248:251], v[40:43], v[136:139]
    v_mfma_f32_16x16x32_bf16 v[140:143], v[248:251], v[56:59], v[140:143]
    v_mfma_f32_16x16x32_bf16 v[136:139], v[252:255], v[44:47], v[136:139]
    v_mfma_f32_16x16x32_bf16 v[140:143], v[252:255], v[60:63], v[140:143]
    s_cmp_eq_u32 s45, 1
    s_cbranch_scc0 .L8
    v_mfma_f32_16x16x32_bf16 v[220:223], v[240:243], v[64:67], 0
    v_mfma_f32_16x16x32_bf16 v[220:223], v[244:247], v[68:71], v[220:223]
    v_mfma_f32_16x16x32_bf16 v[220:223], v[248:251], v[72:75], v[220:223]
    v_mfma_f32_16x16x32_bf16 v[220:223], v[252:255], v[76:79], v[220:223]
.L8:
    s_waitcnt lgkmcnt(3)
    v_mfma_f32_16x16x32_bf16 v[144:147], v[224:227], v[32:35], 0
    ds_read_b128 v[240:243], v16 offset:4096
    v_max3_f32 v20, v20, v128, v129
    v_mfma_f32_16x16x32_bf16 v[148:151], v[224:227], v[48:51], 0
    ds_read_b128 v[244:247], v17 offset:4096
    v_max3_f32 v20, v20, v130, v131
    s_waitcnt lgkmcnt(4)
    v_mfma_f32_16x16x32_bf16 v[144:147], v[228:231], v[36:39], v[144:147]
    ds_read_b128 v[248:251], v18 offset:4096
    v_max3_f32 v21, v21, v132, v133
    v_mfma_f32_16x16x32_bf16 v[148:151], v[228:231], v[52:55], v[148:151]
    ds_read_b128 v[252:255], v19 offset:4096
    v_max3_f32 v21, v21, v134, v135
    s_waitcnt lgkmcnt(5)
    v_mfma_f32_16x16x32_bf16 v[144:147], v[232:235], v[40:43], v[144:147]
    v_mfma_f32_16x16x32_bf16 v[148:151], v[232:235], v[56:59], v[148:151]
    s_waitcnt lgkmcnt(4)
    v_mfma_f32_16x16x32_bf16 v[144:147], v[236:239], v[44:47], v[144:147]
    v_mfma_f32_16x16x32_bf16 v[148:151], v[236:239], v[60:63], v[148:151]
    s_cmp_eq_u32 s45, 2
    s_cbranch_scc0 .L9
    v_mfma_f32_16x16x32_bf16 v[208:211], v[224:227], v[64:67], 0
    v_mfma_f32_16x16x32_bf16 v[208:211], v[228:231], v[68:71], v[208:211]
    v_mfma_f32_16x16x32_bf16 v[208:211], v[232:235], v[72:75], v[208:211]
    v_mfma_f32_16x16x32_bf16 v[208:211], v[236:239], v[76:79], v[208:211]
.L9:
    s_waitcnt lgkmcnt(3)
    v_mfma_f32_16x16x32_bf16 v[152:155], v[240:243], v[32:35], 0
    ds_read_b128 v[224:227], v16 offset:8192
    v_max3_f32 v20, v20, v136, v137
    v_mfma_f32_16x16x32_bf16 v[156:159], v[240:243], v[48:51], 0
    ds_read_b128 v[228:231], v17 offset:8192
    v_max3_f32 v20, v20, v138, v139
    s_waitcnt lgkmcnt(4)
    v_mfma_f32_16x16x32_bf16 v[152:155], v[244:247], v[36:39], v[152:155]
    ds_read_b128 v[232:235], v18 offset:8192
    v_max3_f32 v21, v21, v140, v141
    v_mfma_f32_16x16x32_bf16 v[156:159], v[244:247], v[52:55], v[156:159]
    ds_read_b128 v[236:239], v19 offset:8192
    v_max3_f32 v21, v21, v142, v143
    s_waitcnt lgkmcnt(5)
    v_mfma_f32_16x16x32_bf16 v[152:155], v[248:251], v[40:43], v[152:155]
    v_mfma_f32_16x16x32_bf16 v[156:159], v[248:251], v[56:59], v[156:159]
    s_waitcnt lgkmcnt(4)
    v_mfma_f32_16x16x32_bf16 v[152:155], v[252:255], v[44:47], v[152:155]
    v_mfma_f32_16x16x32_bf16 v[156:159], v[252:255], v[60:63], v[156:159]
    s_cmp_eq_u32 s45, 2
    s_cbranch_scc0 .L10
    v_mfma_f32_16x16x32_bf16 v[212:215], v[240:243], v[64:67], 0
    v_mfma_f32_16x16x32_bf16 v[212:215], v[244:247], v[68:71], v[212:215]
    v_mfma_f32_16x16x32_bf16 v[212:215], v[248:251], v[72:75], v[212:215]
    v_mfma_f32_16x16x32_bf16 v[212:215], v[252:255], v[76:79], v[212:215]
.L10:
    s_waitcnt lgkmcnt(3)
    v_mfma_f32_16x16x32_bf16 v[160:163], v[224:227], v[32:35], 0
    ds_read_b128 v[240:243], v16 offset:12288
    v_max3_f32 v20, v20, v144, v145
    v_mfma_f32_16x16x32_bf16 v[164:167], v[224:227], v[48:51], 0
    ds_read_b128 v[244:247], v17 offset:12288
    v_max3_f32 v20, v20, v146, v147
    s_waitcnt lgkmcnt(4)
    v_mfma_f32_16x16x32_bf16 v[160:163], v[228:231], v[36:39], v[160:163]
    ds_read_b128 v[248:251], v18 offset:12288
    v_max3_f32 v21, v21, v148, v149
    v_mfma_f32_16x16x32_bf16 v[164:167], v[228:231], v[52:55], v[164:167]
    ds_read_b128 v[252:255], v19 offset:12288
    v_max3_f32 v21, v21, v150, v151
    s_waitcnt lgkmcnt(5)
    v_mfma_f32_16x16x32_bf16 v[160:163], v[232:235], v[40:43], v[160:163]
    v_mfma_f32_16x16x32_bf16 v[164:167], v[232:235], v[56:59], v[164:167]
    s_waitcnt lgkmcnt(4)
    v_mfma_f32_16x16x32_bf16 v[160:163], v[236:239], v[44:47], v[160:163]
    v_mfma_f32_16x16x32_bf16 v[164:167], v[236:239], v[60:63], v[164:167]
    s_cmp_eq_u32 s45, 2
    s_cbranch_scc0 .L11
    v_mfma_f32_16x16x32_bf16 v[216:219], v[224:227], v[64:67], 0
    v_mfma_f32_16x16x32_bf16 v[216:219], v[228:231], v[68:71], v[216:219]
    v_mfma_f32_16x16x32_bf16 v[216:219], v[232:235], v[72:75], v[216:219]
    v_mfma_f32_16x16x32_bf16 v[216:219], v[236:239], v[76:79], v[216:219]
.L11:
    s_waitcnt lgkmcnt(0)
    s_barrier
    v_add_u32 v16, 49152, v8
    v_add_u32 v17, 49152, v9
    v_add_u32 v18, 49152, v10
    v_add_u32 v19, 49152, v11
    v_mfma_f32_16x16x32_bf16 v[168:171], v[240:243], v[32:35], 0
    ds_read_b128 v[224:227], v16 offset:0
    v_max3_f32 v20, v20, v152, v153
    v_mfma_f32_16x16x32_bf16 v[172:175], v[240:243], v[48:51], 0
    ds_read_b128 v[228:231], v17 offset:0
    v_max3_f32 v20, v20, v154, v155
    v_mfma_f32_16x16x32_bf16 v[168:171], v[244:247], v[36:39], v[168:171]
    ds_read_b128 v[232:235], v18 offset:0
    v_max3_f32 v21, v21, v156, v157
    v_mfma_f32_16x16x32_bf16 v[172:175], v[244:247], v[52:55], v[172:175]
    ds_read_b128 v[236:239], v19 offset:0
    v_max3_f32 v21, v21, v158, v159
    v_mfma_f32_16x16x32_bf16 v[168:171], v[248:251], v[40:43], v[168:171]
    v_mfma_f32_16x16x32_bf16 v[172:175], v[248:251], v[56:59], v[172:175]
    v_mfma_f32_16x16x32_bf16 v[168:171], v[252:255], v[44:47], v[168:171]
    v_mfma_f32_16x16x32_bf16 v[172:175], v[252:255], v[60:63], v[172:175]
    s_cmp_eq_u32 s45, 2
    s_cbranch_scc0 .L12
    v_mfma_f32_16x16x32_bf16 v[220:223], v[240:243], v[64:67], 0
    v_mfma_f32_16x16x32_bf16 v[220:223], v[244:247], v[68:71], v[220:223]
    v_mfma_f32_16x16x32_bf16 v[220:223], v[248:251], v[72:75], v[220:223]
    v_mfma_f32_16x16x32_bf16 v[220:223], v[252:255], v[76:79], v[220:223]
.L12:
    s_waitcnt lgkmcnt(3)
    v_mfma_f32_16x16x32_bf16 v[176:179], v[224:227], v[32:35], 0
    ds_read_b128 v[240:243], v16 offset:4096
    v_max3_f32 v20, v20, v160, v161
    v_mfma_f32_16x16x32_bf16 v[180:183], v[224:227], v[48:51], 0
    ds_read_b128 v[244:247], v17 offset:4096
    v_max3_f32 v20, v20, v162, v163
    s_waitcnt lgkmcnt(4)
    v_mfma_f32_16x16x32_bf16 v[176:179], v[228:231], v[36:39], v[176:179]
    ds_read_b128 v[248:251], v18 offset:4096
    v_max3_f32 v21, v21, v164, v165
    v_mfma_f32_16x16x32_bf16 v[180:183], v[228:231], v[52:55], v[180:183]
    ds_read_b128 v[252:255], v19 offset:4096
    v_max3_f32 v21, v21, v166, v167
    s_waitcnt lgkmcnt(5)
    v_mfma_f32_16x16x32_bf16 v[176:179], v[232:235], v[40:43], v[176:179]
    v_mfma_f32_16x16x32_bf16 v[180:183], v[232:235], v[56:59], v[180:183]
    s_waitcnt lgkmcnt(4)
    v_mfma_f32_16x16x32_bf16 v[176:179], v[236:239], v[44:47], v[176:179]
    v_mfma_f32_16x16x32_bf16 v[180:183], v[236:239], v[60:63], v[180:183]
    s_cmp_eq_u32 s45, 3
    s_cbranch_scc0 .L13
    v_mfma_f32_16x16x32_bf16 v[208:211], v[224:227], v[64:67], 0
    v_mfma_f32_16x16x32_bf16 v[208:211], v[228:231], v[68:71], v[208:211]
    v_mfma_f32_16x16x32_bf16 v[208:211], v[232:235], v[72:75], v[208:211]
    v_mfma_f32_16x16x32_bf16 v[208:211], v[236:239], v[76:79], v[208:211]
.L13:
    s_waitcnt lgkmcnt(3)
    v_mfma_f32_16x16x32_bf16 v[184:187], v[240:243], v[32:35], 0
    ds_read_b128 v[224:227], v16 offset:8192
    v_max3_f32 v20, v20, v168, v169
    v_mfma_f32_16x16x32_bf16 v[188:191], v[240:243], v[48:51], 0
    ds_read_b128 v[228:231], v17 offset:8192
    v_max3_f32 v20, v20, v170, v171
    s_waitcnt lgkmcnt(4)
    v_mfma_f32_16x16x32_bf16 v[184:187], v[244:247], v[36:39], v[184:187]
    ds_read_b128 v[232:235], v18 offset:8192
    v_max3_f32 v21, v21, v172, v173
    v_mfma_f32_16x16x32_bf16 v[188:191], v[244:247], v[52:55], v[188:191]
    ds_read_b128 v[236:239], v19 offset:8192
    v_max3_f32 v21, v21, v174, v175
    s_waitcnt lgkmcnt(5)
    v_mfma_f32_16x16x32_bf16 v[184:187], v[248:251], v[40:43], v[184:187]
    v_mfma_f32_16x16x32_bf16 v[188:191], v[248:251], v[56:59], v[188:191]
    s_waitcnt lgkmcnt(4)
    v_mfma_f32_16x16x32_bf16 v[184:187], v[252:255], v[44:47], v[184:187]
    v_mfma_f32_16x16x32_bf16 v[188:191], v[252:255], v[60:63], v[188:191]
    s_cmp_eq_u32 s45, 3
    s_cbranch_scc0 .L14
    v_mfma_f32_16x16x32_bf16 v[212:215], v[240:243], v[64:67], 0
    v_mfma_f32_16x16x32_bf16 v[212:215], v[244:247], v[68:71], v[212:215]
    v_mfma_f32_16x16x32_bf16 v[212:215], v[248:251], v[72:75], v[212:215]
    v_mfma_f32_16x16x32_bf16 v[212:215], v[252:255], v[76:79], v[212:215]
.L14:
    s_waitcnt lgkmcnt(3)
    v_mfma_f32_16x16x32_bf16 v[192:195], v[224:227], v[32:35], 0
    ds_read_b128 v[240:243], v16 offset:12288
    v_max3_f32 v20, v20, v176, v177
    v_mfma_f32_16x16x32_bf16 v[196:199], v[224:227], v[48:51], 0
    ds_read_b128 v[244:247], v17 offset:12288
    v_max3_f32 v20, v20, v178, v179
    s_waitcnt lgkmcnt(4)
    v_mfma_f32_16x16x32_bf16 v[192:195], v[228:231], v[36:39], v[192:195]
    ds_read_b128 v[248:251], v18 offset:12288
    v_max3_f32 v21, v21, v180, v181
    v_mfma_f32_16x16x32_bf16 v[196:199], v[228:231], v[52:55], v[196:199]
    ds_read_b128 v[252:255], v19 offset:12288
    v_max3_f32 v21, v21, v182, v183
    s_waitcnt lgkmcnt(5)
    v_mfma_f32_16x16x32_bf16 v[192:195], v[232:235], v[40:43], v[192:195]
    v_mfma_f32_16x16x32_bf16 v[196:199], v[232:235], v[56:59], v[196:199]
    s_waitcnt lgkmcnt(4)
    v_mfma_f32_16x16x32_bf16 v[192:195], v[236:239], v[44:47], v[192:195]
    v_mfma_f32_16x16x32_bf16 v[196:199], v[236:239], v[60:63], v[196:199]
    s_cmp_eq_u32 s45, 3
    s_cbranch_scc0 .L15
    v_mfma_f32_16x16x32_bf16 v[216:219], v[224:227], v[64:67], 0
    v_mfma_f32_16x16x32_bf16 v[216:219], v[228:231], v[68:71], v[216:219]
    v_mfma_f32_16x16x32_bf16 v[216:219], v[232:235], v[72:75], v[216:219]
    v_mfma_f32_16x16x32_bf16 v[216:219], v[236:239], v[76:79], v[216:219]
.L15:
    s_waitcnt lgkmcnt(3)
    v_mfma_f32_16x16x32_bf16 v[200:203], v[240:243], v[32:35], 0
    v_max3_f32 v20, v20, v184, v185
    v_mfma_f32_16x16x32_bf16 v[204:207], v[240:243], v[48:51], 0
    v_max3_f32 v20, v20, v186, v187
    s_waitcnt lgkmcnt(2)
    v_mfma_f32_16x16x32_bf16 v[200:203], v[244:247], v[36:39], v[200:203]
    v_max3_f32 v21, v21, v188, v189
    v_mfma_f32_16x16x32_bf16 v[204:207], v[244:247], v[52:55], v[204:207]
    v_max3_f32 v21, v21, v190, v191
    s_waitcnt lgkmcnt(1)
    v_mfma_f32_16x16x32_bf16 v[200:203], v[248:251], v[40:43], v[200:203]
    v_mfma_f32_16x16x32_bf16 v[204:207], v[248:251], v[56:59], v[204:207]
    s_waitcnt lgkmcnt(0)
    v_mfma_f32_16x16x32_bf16 v[200:203], v[252:255], v[44:47], v[200:203]
    v_mfma_f32_16x16x32_bf16 v[204:207], v[252:255], v[60:63], v[204:207]
    s_cmp_eq_u32 s45, 3
    s_cbranch_scc0 .L16
    v_mfma_f32_16x16x32_bf16 v[220:223], v[240:243], v[64:67], 0
    v_mfma_f32_16x16x32_bf16 v[220:223], v[244:247], v[68:71], v[220:223]
    v_mfma_f32_16x16x32_bf16 v[220:223], v[248:251], v[72:75], v[220:223]
    v_mfma_f32_16x16x32_bf16 v[220:223], v[252:255], v[76:79], v[220:223]
.L16:
    s_waitcnt lgkmcnt(0)
    s_barrier
    s_mov_b32 s53, 0x3e0293ee
    v_mov_b32 v14, s53
    v_mov_b32 v15, s53
    v_max3_f32 v20, v20, v192, v193
    v_max3_f32 v20, v20, v194, v195
    v_max3_f32 v21, v21, v196, v197
    v_max3_f32 v21, v21, v198, v199
    v_max3_f32 v20, v20, v200, v201
    v_max3_f32 v20, v20, v202, v203
    v_max3_f32 v21, v21, v204, v205
    v_max3_f32 v21, v21, v206, v207
    v_max3_f32 v22, v208, v209, v210
    v_max3_f32 v22, v22, v211, v212
    v_max3_f32 v22, v22, v213, v214
    v_max3_f32 v22, v22, v215, v216
    v_max3_f32 v22, v22, v217, v218
    v_max3_f32 v22, v22, v219, v220
    v_max3_f32 v22, v22, v221, v222
    v_max_f32 v22, v22, v223
    v_mov_b32 v23, v20
    v_mov_b32 v24, v21
    v_mov_b32 v25, v22
    s_nop 1
    v_permlane32_swap_b32 v20, v23
    v_permlane32_swap_b32 v21, v24
    v_permlane32_swap_b32 v22, v25
    v_max_f32 v20, v20, v23
    v_max_f32 v21, v21, v24
    v_max_f32 v22, v22, v25
    v_mov_b32 v23, v20
    v_mov_b32 v24, v21
    v_mov_b32 v25, v22
    s_nop 1
    v_permlane16_swap_b32 v20, v23
    v_permlane16_swap_b32 v21, v24
    v_permlane16_swap_b32 v22, v25
    v_max_f32 v20, v20, v23
    v_max_f32 v21, v21, v24
    v_max_f32 v22, v22, v25
    v_mul_f32 v248, s53, v20
    v_sub_f32 v248, 0, v248
    v_mov_b32 v249, v248
    v_mul_f32 v250, s53, v21
    v_sub_f32 v250, 0, v250
    v_mov_b32 v251, v250
    v_mul_f32 v252, s53, v22
    v_sub_f32 v252, 0, v252
    v_mov_b32 v253, v252
    v_pk_fma_f32 v[208:209], v[208:209], v[14:15], v[252:253]
    v_pk_fma_f32 v[210:211], v[210:211], v[14:15], v[252:253]
    v_pk_fma_f32 v[212:213], v[212:213], v[14:15], v[252:253]
    v_pk_fma_f32 v[214:215], v[214:215], v[14:15], v[252:253]
    v_pk_fma_f32 v[216:217], v[216:217], v[14:15], v[252:253]
    v_pk_fma_f32 v[218:219], v[218:219], v[14:15], v[252:253]
    v_pk_fma_f32 v[220:221], v[220:221], v[14:15], v[252:253]
    v_pk_fma_f32 v[222:223], v[222:223], v[14:15], v[252:253]
    v_exp_f32 v208, v208
    v_exp_f32 v209, v209
    v_exp_f32 v210, v210
    v_exp_f32 v211, v211
    v_exp_f32 v212, v212
    v_exp_f32 v213, v213
    v_exp_f32 v214, v214
    v_exp_f32 v215, v215
    v_exp_f32 v216, v216
    v_exp_f32 v217, v217
    v_exp_f32 v218, v218
    v_exp_f32 v219, v219
    v_exp_f32 v220, v220
    v_exp_f32 v221, v221
    v_exp_f32 v222, v222
    v_exp_f32 v223, v223
    s_nop 0
    v_cvt_pk_bf16_f32 v208, v208, v209
    v_cvt_pk_bf16_f32 v209, v210, v211
    v_cvt_pk_bf16_f32 v210, v212, v213
    v_cvt_pk_bf16_f32 v211, v214, v215
    v_cvt_pk_bf16_f32 v212, v216, v217
    v_cvt_pk_bf16_f32 v213, v218, v219
    v_cvt_pk_bf16_f32 v214, v220, v221
    v_cvt_pk_bf16_f32 v215, v222, v223
    v_pk_fma_f32 v[80:81], v[80:81], v[14:15], v[248:249]
    v_pk_fma_f32 v[82:83], v[82:83], v[14:15], v[248:249]
    v_pk_fma_f32 v[88:89], v[88:89], v[14:15], v[248:249]
    v_pk_fma_f32 v[90:91], v[90:91], v[14:15], v[248:249]
    v_exp_f32 v80, v80
    v_exp_f32 v81, v81
    v_exp_f32 v82, v82
    v_exp_f32 v83, v83
    v_exp_f32 v88, v88
    v_exp_f32 v89, v89
    v_exp_f32 v90, v90
    v_exp_f32 v91, v91
    s_nop 0
    v_cvt_pk_bf16_f32 v32, v80, v81
    v_cvt_pk_bf16_f32 v33, v82, v83
    v_cvt_pk_bf16_f32 v34, v88, v89
    v_cvt_pk_bf16_f32 v35, v90, v91
    v_pk_fma_f32 v[84:85], v[84:85], v[14:15], v[250:251]
    v_pk_fma_f32 v[86:87], v[86:87], v[14:15], v[250:251]
    v_pk_fma_f32 v[92:93], v[92:93], v[14:15], v[250:251]
    v_pk_fma_f32 v[94:95], v[94:95], v[14:15], v[250:251]
    v_exp_f32 v84, v84
    v_exp_f32 v85, v85
    v_exp_f32 v86, v86
    v_exp_f32 v87, v87
    v_exp_f32 v92, v92
    v_exp_f32 v93, v93
    v_exp_f32 v94, v94
    v_exp_f32 v95, v95
    s_nop 0
    v_cvt_pk_bf16_f32 v36, v84, v85
    v_cvt_pk_bf16_f32 v37, v86, v87
    v_cvt_pk_bf16_f32 v38, v92, v93
    v_cvt_pk_bf16_f32 v39, v94, v95
    v_pk_fma_f32 v[96:97], v[96:97], v[14:15], v[248:249]
    v_pk_fma_f32 v[98:99], v[98:99], v[14:15], v[248:249]
    v_pk_fma_f32 v[104:105], v[104:105], v[14:15], v[248:249]
    v_pk_fma_f32 v[106:107], v[106:107], v[14:15], v[248:249]
    v_exp_f32 v96, v96
    v_exp_f32 v97, v97
    v_exp_f32 v98, v98
    v_exp_f32 v99, v99
    v_exp_f32 v104, v104
    v_exp_f32 v105, v105
    v_exp_f32 v106, v106
    v_exp_f32 v107, v107
    s_nop 0
    v_cvt_pk_bf16_f32 v40, v96, v97
    v_cvt_pk_bf16_f32 v41, v98, v99
    v_cvt_pk_bf16_f32 v42, v104, v105
    v_cvt_pk_bf16_f32 v43, v106, v107
    v_pk_fma_f32 v[100:101], v[100:101], v[14:15], v[250:251]
    v_pk_fma_f32 v[102:103], v[102:103], v[14:15], v[250:251]
    v_pk_fma_f32 v[108:109], v[108:109], v[14:15], v[250:251]
    v_pk_fma_f32 v[110:111], v[110:111], v[14:15], v[250:251]
    v_exp_f32 v100, v100
    v_exp_f32 v101, v101
    v_exp_f32 v102, v102
    v_exp_f32 v103, v103
    v_exp_f32 v108, v108
    v_exp_f32 v109, v109
    v_exp_f32 v110, v110
    v_exp_f32 v111, v111
    s_nop 0
    v_cvt_pk_bf16_f32 v44, v100, v101
    v_cvt_pk_bf16_f32 v45, v102, v103
    v_cvt_pk_bf16_f32 v46, v108, v109
    v_cvt_pk_bf16_f32 v47, v110, v111
    v_pk_fma_f32 v[112:113], v[112:113], v[14:15], v[248:249]
    v_pk_fma_f32 v[114:115], v[114:115], v[14:15], v[248:249]
    v_pk_fma_f32 v[120:121], v[120:121], v[14:15], v[248:249]
    v_pk_fma_f32 v[122:123], v[122:123], v[14:15], v[248:249]
    v_exp_f32 v112, v112
    v_exp_f32 v113, v113
    v_exp_f32 v114, v114
    v_exp_f32 v115, v115
    v_exp_f32 v120, v120
    v_exp_f32 v121, v121
    v_exp_f32 v122, v122
    v_exp_f32 v123, v123
    s_nop 0
    v_cvt_pk_bf16_f32 v48, v112, v113
    v_cvt_pk_bf16_f32 v49, v114, v115
    v_cvt_pk_bf16_f32 v50, v120, v121
    v_cvt_pk_bf16_f32 v51, v122, v123
    v_pk_fma_f32 v[116:117], v[116:117], v[14:15], v[250:251]
    v_pk_fma_f32 v[118:119], v[118:119], v[14:15], v[250:251]
    v_pk_fma_f32 v[124:125], v[124:125], v[14:15], v[250:251]
    v_pk_fma_f32 v[126:127], v[126:127], v[14:15], v[250:251]
    v_exp_f32 v116, v116
    v_exp_f32 v117, v117
    v_exp_f32 v118, v118
    v_exp_f32 v119, v119
    v_exp_f32 v124, v124
    v_exp_f32 v125, v125
    v_exp_f32 v126, v126
    v_exp_f32 v127, v127
    s_nop 0
    v_cvt_pk_bf16_f32 v52, v116, v117
    v_cvt_pk_bf16_f32 v53, v118, v119
    v_cvt_pk_bf16_f32 v54, v124, v125
    v_cvt_pk_bf16_f32 v55, v126, v127
    v_pk_fma_f32 v[128:129], v[128:129], v[14:15], v[248:249]
    v_pk_fma_f32 v[130:131], v[130:131], v[14:15], v[248:249]
    v_pk_fma_f32 v[136:137], v[136:137], v[14:15], v[248:249]
    v_pk_fma_f32 v[138:139], v[138:139], v[14:15], v[248:249]
    v_exp_f32 v128, v128
    v_exp_f32 v129, v129
    v_exp_f32 v130, v130
    v_exp_f32 v131, v131
    v_exp_f32 v136, v136
    v_exp_f32 v137, v137
    v_exp_f32 v138, v138
    v_exp_f32 v139, v139
    s_nop 0
    v_cvt_pk_bf16_f32 v56, v128, v129
    v_cvt_pk_bf16_f32 v57, v130, v131
    v_cvt_pk_bf16_f32 v58, v136, v137
    v_cvt_pk_bf16_f32 v59, v138, v139
    v_pk_fma_f32 v[132:133], v[132:133], v[14:15], v[250:251]
    v_pk_fma_f32 v[134:135], v[134:135], v[14:15], v[250:251]
    v_pk_fma_f32 v[140:141], v[140:141], v[14:15], v[250:251]
    v_pk_fma_f32 v[142:143], v[142:143], v[14:15], v[250:251]
    v_exp_f32 v132, v132
    v_exp_f32 v133, v133
    v_exp_f32 v134, v134
    v_exp_f32 v135, v135
    v_exp_f32 v140, v140
    v_exp_f32 v141, v141
    v_exp_f32 v142, v142
    v_exp_f32 v143, v143
    s_nop 0
    v_cvt_pk_bf16_f32 v60, v132, v133
    v_cvt_pk_bf16_f32 v61, v134, v135
    v_cvt_pk_bf16_f32 v62, v140, v141
    v_cvt_pk_bf16_f32 v63, v142, v143
    s_barrier
    v_pk_fma_f32 v[144:145], v[144:145], v[14:15], v[248:249]
    v_pk_fma_f32 v[146:147], v[146:147], v[14:15], v[248:249]
    v_pk_fma_f32 v[152:153], v[152:153], v[14:15], v[248:249]
    v_pk_fma_f32 v[154:155], v[154:155], v[14:15], v[248:249]
    v_exp_f32 v144, v144
    v_exp_f32 v145, v145
    v_exp_f32 v146, v146
    v_exp_f32 v147, v147
    v_exp_f32 v152, v152
    v_exp_f32 v153, v153
    v_exp_f32 v154, v154
    v_exp_f32 v155, v155
    s_nop 0
    v_cvt_pk_bf16_f32 v64, v144, v145
    v_cvt_pk_bf16_f32 v65, v146, v147
    v_cvt_pk_bf16_f32 v66, v152, v153
    v_cvt_pk_bf16_f32 v67, v154, v155
    v_pk_fma_f32 v[148:149], v[148:149], v[14:15], v[250:251]
    v_pk_fma_f32 v[150:151], v[150:151], v[14:15], v[250:251]
    v_pk_fma_f32 v[156:157], v[156:157], v[14:15], v[250:251]
    v_pk_fma_f32 v[158:159], v[158:159], v[14:15], v[250:251]
    v_exp_f32 v148, v148
    v_exp_f32 v149, v149
    v_exp_f32 v150, v150
    v_exp_f32 v151, v151
    v_exp_f32 v156, v156
    v_exp_f32 v157, v157
    v_exp_f32 v158, v158
    v_exp_f32 v159, v159
    s_nop 0
    v_cvt_pk_bf16_f32 v68, v148, v149
    v_cvt_pk_bf16_f32 v69, v150, v151
    v_cvt_pk_bf16_f32 v70, v156, v157
    v_cvt_pk_bf16_f32 v71, v158, v159
    v_pk_fma_f32 v[160:161], v[160:161], v[14:15], v[248:249]
    v_pk_fma_f32 v[162:163], v[162:163], v[14:15], v[248:249]
    v_pk_fma_f32 v[168:169], v[168:169], v[14:15], v[248:249]
    v_pk_fma_f32 v[170:171], v[170:171], v[14:15], v[248:249]
    v_exp_f32 v160, v160
    v_exp_f32 v161, v161
    v_exp_f32 v162, v162
    v_exp_f32 v163, v163
    v_exp_f32 v168, v168
    v_exp_f32 v169, v169
    v_exp_f32 v170, v170
    v_exp_f32 v171, v171
    s_nop 0
    v_cvt_pk_bf16_f32 v72, v160, v161
    v_cvt_pk_bf16_f32 v73, v162, v163
    v_cvt_pk_bf16_f32 v74, v168, v169
    v_cvt_pk_bf16_f32 v75, v170, v171
    v_pk_fma_f32 v[164:165], v[164:165], v[14:15], v[250:251]
    v_pk_fma_f32 v[166:167], v[166:167], v[14:15], v[250:251]
    v_pk_fma_f32 v[172:173], v[172:173], v[14:15], v[250:251]
    v_pk_fma_f32 v[174:175], v[174:175], v[14:15], v[250:251]
    v_exp_f32 v164, v164
    v_exp_f32 v165, v165
    v_exp_f32 v166, v166
    v_exp_f32 v167, v167
    v_exp_f32 v172, v172
    v_exp_f32 v173, v173
    v_exp_f32 v174, v174
    v_exp_f32 v175, v175
    s_nop 0
    v_cvt_pk_bf16_f32 v76, v164, v165
    v_cvt_pk_bf16_f32 v77, v166, v167
    v_cvt_pk_bf16_f32 v78, v172, v173
    v_cvt_pk_bf16_f32 v79, v174, v175
    v_pk_fma_f32 v[176:177], v[176:177], v[14:15], v[248:249]
    v_pk_fma_f32 v[178:179], v[178:179], v[14:15], v[248:249]
    v_pk_fma_f32 v[184:185], v[184:185], v[14:15], v[248:249]
    v_pk_fma_f32 v[186:187], v[186:187], v[14:15], v[248:249]
    v_exp_f32 v176, v176
    v_exp_f32 v177, v177
    v_exp_f32 v178, v178
    v_exp_f32 v179, v179
    v_exp_f32 v184, v184
    v_exp_f32 v185, v185
    v_exp_f32 v186, v186
    v_exp_f32 v187, v187
    s_nop 0
    v_cvt_pk_bf16_f32 v224, v176, v177
    v_cvt_pk_bf16_f32 v225, v178, v179
    v_cvt_pk_bf16_f32 v226, v184, v185
    v_cvt_pk_bf16_f32 v227, v186, v187
    v_pk_fma_f32 v[180:181], v[180:181], v[14:15], v[250:251]
    v_pk_fma_f32 v[182:183], v[182:183], v[14:15], v[250:251]
    v_pk_fma_f32 v[188:189], v[188:189], v[14:15], v[250:251]
    v_pk_fma_f32 v[190:191], v[190:191], v[14:15], v[250:251]
    v_exp_f32 v180, v180
    v_exp_f32 v181, v181
    v_exp_f32 v182, v182
    v_exp_f32 v183, v183
    v_exp_f32 v188, v188
    v_exp_f32 v189, v189
    v_exp_f32 v190, v190
    v_exp_f32 v191, v191
    s_nop 0
    v_cvt_pk_bf16_f32 v228, v180, v181
    v_cvt_pk_bf16_f32 v229, v182, v183
    v_cvt_pk_bf16_f32 v230, v188, v189
    v_cvt_pk_bf16_f32 v231, v190, v191
    v_pk_fma_f32 v[192:193], v[192:193], v[14:15], v[248:249]
    v_pk_fma_f32 v[194:195], v[194:195], v[14:15], v[248:249]
    v_pk_fma_f32 v[200:201], v[200:201], v[14:15], v[248:249]
    v_pk_fma_f32 v[202:203], v[202:203], v[14:15], v[248:249]
    v_exp_f32 v192, v192
    v_exp_f32 v193, v193
    v_exp_f32 v194, v194
    v_exp_f32 v195, v195
    v_exp_f32 v200, v200
    v_exp_f32 v201, v201
    v_exp_f32 v202, v202
    v_exp_f32 v203, v203
    s_nop 0
    v_cvt_pk_bf16_f32 v232, v192, v193
    v_cvt_pk_bf16_f32 v233, v194, v195
    v_cvt_pk_bf16_f32 v234, v200, v201
    v_cvt_pk_bf16_f32 v235, v202, v203
    v_pk_fma_f32 v[196:197], v[196:197], v[14:15], v[250:251]
    v_pk_fma_f32 v[198:199], v[198:199], v[14:15], v[250:251]
    v_pk_fma_f32 v[204:205], v[204:205], v[14:15], v[250:251]
    v_pk_fma_f32 v[206:207], v[206:207], v[14:15], v[250:251]
    v_exp_f32 v196, v196
    v_exp_f32 v197, v197
    v_exp_f32 v198, v198
    v_exp_f32 v199, v199
    v_exp_f32 v204, v204
    v_exp_f32 v205, v205
    v_exp_f32 v206, v206
    v_exp_f32 v207, v207
    s_nop 0
    v_cvt_pk_bf16_f32 v236, v196, v197
    v_cvt_pk_bf16_f32 v237, v198, v199
    v_cvt_pk_bf16_f32 v238, v204, v205
    v_cvt_pk_bf16_f32 v239, v206, v207
    v_mov_b32 v240, v208
    v_mov_b32 v241, v209
    v_mov_b32 v242, v210
    v_mov_b32 v243, v211
    v_mov_b32 v244, v212
    v_mov_b32 v245, v213
    v_mov_b32 v246, v214
    v_mov_b32 v247, v215
    v_lshl_add_u32 v1, v28, 2, v29
    v_lshlrev_b32 v1, 8, v1
    v_lshl_add_u32 v1, v30, 3, v1
    v_xor_b32 v8, 0, v31
    v_lshl_add_u32 v8, v8, 5, v1
    v_xor_b32 v9, 1, v31
    v_lshl_add_u32 v9, v9, 5, v1
    v_xor_b32 v10, 2, v31
    v_lshl_add_u32 v10, v10, 5, v1
    v_xor_b32 v11, 3, v31
    v_lshl_add_u32 v11, v11, 5, v1
    v_xor_b32 v12, 4, v31
    v_lshl_add_u32 v12, v12, 5, v1
    v_xor_b32 v13, 5, v31
    v_lshl_add_u32 v13, v13, 5, v1
    v_xor_b32 v14, 6, v31
    v_lshl_add_u32 v14, v14, 5, v1
    v_xor_b32 v15, 7, v31
    v_lshl_add_u32 v15, v15, 5, v1
    v_mov_b32 v28, 0x3f803f80
    v_mov_b32 v29, 0x3f803f80
    v_mov_b32 v30, 0x3f803f80
    v_mov_b32 v31, 0x3f803f80
    s_barrier
    v_add_u32 v16, 65536, v8
    v_add_u32 v17, 65536, v9
    v_add_u32 v18, 65536, v10
    v_add_u32 v19, 65536, v11
    v_add_u32 v20, 65536, v12
    v_add_u32 v21, 65536, v13
    v_add_u32 v22, 65536, v14
    v_add_u32 v23, 65536, v15
    ds_read_b64_tr_b16 v[188:189], v16 offset:0
    ds_read_b64_tr_b16 v[190:191], v16 offset:4096
    ds_read_b64_tr_b16 v[192:193], v17 offset:0
    ds_read_b64_tr_b16 v[194:195], v17 offset:4096
    ds_read_b64_tr_b16 v[196:197], v18 offset:0
    ds_read_b64_tr_b16 v[198:199], v18 offset:4096
    ds_read_b64_tr_b16 v[200:201], v19 offset:0
    ds_read_b64_tr_b16 v[202:203], v19 offset:4096
    s_waitcnt lgkmcnt(6)
    v_mfma_f32_16x16x32_bf16 v[80:83], v[188:191], v[32:35], 0
    ds_read_b64_tr_b16 v[204:205], v20 offset:0
    ds_read_b64_tr_b16 v[206:207], v20 offset:4096
    v_mfma_f32_16x16x32_bf16 v[84:87], v[188:191], v[36:39], 0
    ds_read_b64_tr_b16 v[208:209], v21 offset:0
    ds_read_b64_tr_b16 v[210:211], v21 offset:4096
    s_waitcnt lgkmcnt(8)
    v_mfma_f32_16x16x32_bf16 v[88:91], v[192:195], v[32:35], 0
    ds_read_b64_tr_b16 v[212:213], v22 offset:0
    ds_read_b64_tr_b16 v[214:215], v22 offset:4096
    v_mfma_f32_16x16x32_bf16 v[92:95], v[192:195], v[36:39], 0
    ds_read_b64_tr_b16 v[216:217], v23 offset:0
    ds_read_b64_tr_b16 v[218:219], v23 offset:4096
    s_waitcnt lgkmcnt(10)
    v_mfma_f32_16x16x32_bf16 v[96:99], v[196:199], v[32:35], 0
    v_mfma_f32_16x16x32_bf16 v[100:103], v[196:199], v[36:39], 0
    s_waitcnt lgkmcnt(8)
    v_mfma_f32_16x16x32_bf16 v[104:107], v[200:203], v[32:35], 0
    v_mfma_f32_16x16x32_bf16 v[108:111], v[200:203], v[36:39], 0
    v_mfma_f32_16x16x32_bf16 v[144:147], v[28:31], v[32:35], 0
    s_cmp_eq_u32 s45, 0
    s_cbranch_scc0 .L17
    v_mfma_f32_16x16x32_bf16 v[152:155], v[188:191], v[240:243], 0
    v_mfma_f32_16x16x32_bf16 v[156:159], v[192:195], v[240:243], 0
    v_mfma_f32_16x16x32_bf16 v[160:163], v[196:199], v[240:243], 0
    v_mfma_f32_16x16x32_bf16 v[164:167], v[200:203], v[240:243], 0
    v_mfma_f32_16x16x32_bf16 v[184:187], v[28:31], v[240:243], 0
.L17:
    s_waitcnt lgkmcnt(6)
    v_mfma_f32_16x16x32_bf16 v[112:115], v[204:207], v[32:35], 0
    ds_read_b64_tr_b16 v[188:189], v16 offset:8192
    ds_read_b64_tr_b16 v[190:191], v16 offset:12288
    v_mfma_f32_16x16x32_bf16 v[116:119], v[204:207], v[36:39], 0
    ds_read_b64_tr_b16 v[192:193], v17 offset:8192
    ds_read_b64_tr_b16 v[194:195], v17 offset:12288
    s_waitcnt lgkmcnt(8)
    v_mfma_f32_16x16x32_bf16 v[120:123], v[208:211], v[32:35], 0
    ds_read_b64_tr_b16 v[196:197], v18 offset:8192
    ds_read_b64_tr_b16 v[198:199], v18 offset:12288
    v_mfma_f32_16x16x32_bf16 v[124:127], v[208:211], v[36:39], 0
    ds_read_b64_tr_b16 v[200:201], v19 offset:8192
    ds_read_b64_tr_b16 v[202:203], v19 offset:12288
    s_waitcnt lgkmcnt(10)
    v_mfma_f32_16x16x32_bf16 v[128:131], v[212:215], v[32:35], 0
    v_mfma_f32_16x16x32_bf16 v[132:135], v[212:215], v[36:39], 0
    s_waitcnt lgkmcnt(8)
    v_mfma_f32_16x16x32_bf16 v[136:139], v[216:219], v[32:35], 0
    v_mfma_f32_16x16x32_bf16 v[140:143], v[216:219], v[36:39], 0
    v_mfma_f32_16x16x32_bf16 v[148:151], v[28:31], v[36:39], 0
    s_cmp_eq_u32 s45, 0
    s_cbranch_scc0 .L18
    v_mfma_f32_16x16x32_bf16 v[168:171], v[204:207], v[240:243], 0
    v_mfma_f32_16x16x32_bf16 v[172:175], v[208:211], v[240:243], 0
    v_mfma_f32_16x16x32_bf16 v[176:179], v[212:215], v[240:243], 0
    v_mfma_f32_16x16x32_bf16 v[180:183], v[216:219], v[240:243], 0
.L18:
    s_waitcnt lgkmcnt(6)
    v_mfma_f32_16x16x32_bf16 v[80:83], v[188:191], v[40:43], v[80:83]
    ds_read_b64_tr_b16 v[204:205], v20 offset:8192
    ds_read_b64_tr_b16 v[206:207], v20 offset:12288
    v_mfma_f32_16x16x32_bf16 v[84:87], v[188:191], v[44:47], v[84:87]
    ds_read_b64_tr_b16 v[208:209], v21 offset:8192
    ds_read_b64_tr_b16 v[210:211], v21 offset:12288
    s_waitcnt lgkmcnt(8)
    v_mfma_f32_16x16x32_bf16 v[88:91], v[192:195], v[40:43], v[88:91]
    ds_read_b64_tr_b16 v[212:213], v22 offset:8192
    ds_read_b64_tr_b16 v[214:215], v22 offset:12288
    v_mfma_f32_16x16x32_bf16 v[92:95], v[192:195], v[44:47], v[92:95]
    ds_read_b64_tr_b16 v[216:217], v23 offset:8192
    ds_read_b64_tr_b16 v[218:219], v23 offset:12288
    s_waitcnt lgkmcnt(10)
    v_mfma_f32_16x16x32_bf16 v[96:99], v[196:199], v[40:43], v[96:99]
    v_mfma_f32_16x16x32_bf16 v[100:103], v[196:199], v[44:47], v[100:103]
    s_waitcnt lgkmcnt(8)
    v_mfma_f32_16x16x32_bf16 v[104:107], v[200:203], v[40:43], v[104:107]
    v_mfma_f32_16x16x32_bf16 v[108:111], v[200:203], v[44:47], v[108:111]
    v_mfma_f32_16x16x32_bf16 v[144:147], v[28:31], v[40:43], v[144:147]
    s_cmp_eq_u32 s45, 0
    s_cbranch_scc0 .L19
    v_mfma_f32_16x16x32_bf16 v[152:155], v[188:191], v[244:247], v[152:155]
    v_mfma_f32_16x16x32_bf16 v[156:159], v[192:195], v[244:247], v[156:159]
    v_mfma_f32_16x16x32_bf16 v[160:163], v[196:199], v[244:247], v[160:163]
    v_mfma_f32_16x16x32_bf16 v[164:167], v[200:203], v[244:247], v[164:167]
    v_mfma_f32_16x16x32_bf16 v[184:187], v[28:31], v[244:247], v[184:187]
.L19:
    s_waitcnt lgkmcnt(0)
    s_barrier
    v_add_u32 v16, 135168, v8
    v_add_u32 v17, 135168, v9
    v_add_u32 v18, 135168, v10
    v_add_u32 v19, 135168, v11
    v_add_u32 v20, 135168, v12
    v_add_u32 v21, 135168, v13
    v_add_u32 v22, 135168, v14
    v_add_u32 v23, 135168, v15
    v_mfma_f32_16x16x32_bf16 v[112:115], v[204:207], v[40:43], v[112:115]
    ds_read_b64_tr_b16 v[188:189], v16 offset:0
    ds_read_b64_tr_b16 v[190:191], v16 offset:4096
    v_mfma_f32_16x16x32_bf16 v[116:119], v[204:207], v[44:47], v[116:119]
    ds_read_b64_tr_b16 v[192:193], v17 offset:0
    ds_read_b64_tr_b16 v[194:195], v17 offset:4096
    v_mfma_f32_16x16x32_bf16 v[120:123], v[208:211], v[40:43], v[120:123]
    ds_read_b64_tr_b16 v[196:197], v18 offset:0
    ds_read_b64_tr_b16 v[198:199], v18 offset:4096
    v_mfma_f32_16x16x32_bf16 v[124:127], v[208:211], v[44:47], v[124:127]
    ds_read_b64_tr_b16 v[200:201], v19 offset:0
    ds_read_b64_tr_b16 v[202:203], v19 offset:4096
    v_mfma_f32_16x16x32_bf16 v[128:131], v[212:215], v[40:43], v[128:131]
    v_mfma_f32_16x16x32_bf16 v[132:135], v[212:215], v[44:47], v[132:135]
    v_mfma_f32_16x16x32_bf16 v[136:139], v[216:219], v[40:43], v[136:139]
    v_mfma_f32_16x16x32_bf16 v[140:143], v[216:219], v[44:47], v[140:143]
    v_mfma_f32_16x16x32_bf16 v[148:151], v[28:31], v[44:47], v[148:151]
    s_cmp_eq_u32 s45, 0
    s_cbranch_scc0 .L20
    v_mfma_f32_16x16x32_bf16 v[168:171], v[204:207], v[244:247], v[168:171]
    v_mfma_f32_16x16x32_bf16 v[172:175], v[208:211], v[244:247], v[172:175]
    v_mfma_f32_16x16x32_bf16 v[176:179], v[212:215], v[244:247], v[176:179]
    v_mfma_f32_16x16x32_bf16 v[180:183], v[216:219], v[244:247], v[180:183]
.L20:
    s_waitcnt lgkmcnt(6)
    v_mfma_f32_16x16x32_bf16 v[80:83], v[188:191], v[48:51], v[80:83]
    ds_read_b64_tr_b16 v[204:205], v20 offset:0
    ds_read_b64_tr_b16 v[206:207], v20 offset:4096
    v_mfma_f32_16x16x32_bf16 v[84:87], v[188:191], v[52:55], v[84:87]
    ds_read_b64_tr_b16 v[208:209], v21 offset:0
    ds_read_b64_tr_b16 v[210:211], v21 offset:4096
    s_waitcnt lgkmcnt(8)
    v_mfma_f32_16x16x32_bf16 v[88:91], v[192:195], v[48:51], v[88:91]
    ds_read_b64_tr_b16 v[212:213], v22 offset:0
    ds_read_b64_tr_b16 v[214:215], v22 offset:4096
    v_mfma_f32_16x16x32_bf16 v[92:95], v[192:195], v[52:55], v[92:95]
    ds_read_b64_tr_b16 v[216:217], v23 offset:0
    ds_read_b64_tr_b16 v[218:219], v23 offset:4096
    s_waitcnt lgkmcnt(10)
    v_mfma_f32_16x16x32_bf16 v[96:99], v[196:199], v[48:51], v[96:99]
    v_mfma_f32_16x16x32_bf16 v[100:103], v[196:199], v[52:55], v[100:103]
    s_waitcnt lgkmcnt(8)
    v_mfma_f32_16x16x32_bf16 v[104:107], v[200:203], v[48:51], v[104:107]
    v_mfma_f32_16x16x32_bf16 v[108:111], v[200:203], v[52:55], v[108:111]
    v_mfma_f32_16x16x32_bf16 v[144:147], v[28:31], v[48:51], v[144:147]
    s_cmp_eq_u32 s45, 1
    s_cbranch_scc0 .L21
    v_mfma_f32_16x16x32_bf16 v[152:155], v[188:191], v[240:243], 0
    v_mfma_f32_16x16x32_bf16 v[156:159], v[192:195], v[240:243], 0
    v_mfma_f32_16x16x32_bf16 v[160:163], v[196:199], v[240:243], 0
    v_mfma_f32_16x16x32_bf16 v[164:167], v[200:203], v[240:243], 0
    v_mfma_f32_16x16x32_bf16 v[184:187], v[28:31], v[240:243], 0
.L21:
    s_waitcnt lgkmcnt(6)
    v_mfma_f32_16x16x32_bf16 v[112:115], v[204:207], v[48:51], v[112:115]
    ds_read_b64_tr_b16 v[188:189], v16 offset:8192
    ds_read_b64_tr_b16 v[190:191], v16 offset:12288
    v_mfma_f32_16x16x32_bf16 v[116:119], v[204:207], v[52:55], v[116:119]
    ds_read_b64_tr_b16 v[192:193], v17 offset:8192
    ds_read_b64_tr_b16 v[194:195], v17 offset:12288
    s_waitcnt lgkmcnt(8)
    v_mfma_f32_16x16x32_bf16 v[120:123], v[208:211], v[48:51], v[120:123]
    ds_read_b64_tr_b16 v[196:197], v18 offset:8192
    ds_read_b64_tr_b16 v[198:199], v18 offset:12288
    v_mfma_f32_16x16x32_bf16 v[124:127], v[208:211], v[52:55], v[124:127]
    ds_read_b64_tr_b16 v[200:201], v19 offset:8192
    ds_read_b64_tr_b16 v[202:203], v19 offset:12288
    s_waitcnt lgkmcnt(10)
    v_mfma_f32_16x16x32_bf16 v[128:131], v[212:215], v[48:51], v[128:131]
    v_mfma_f32_16x16x32_bf16 v[132:135], v[212:215], v[52:55], v[132:135]
    s_waitcnt lgkmcnt(8)
    v_mfma_f32_16x16x32_bf16 v[136:139], v[216:219], v[48:51], v[136:139]
    v_mfma_f32_16x16x32_bf16 v[140:143], v[216:219], v[52:55], v[140:143]
    v_mfma_f32_16x16x32_bf16 v[148:151], v[28:31], v[52:55], v[148:151]
    s_cmp_eq_u32 s45, 1
    s_cbranch_scc0 .L22
    v_mfma_f32_16x16x32_bf16 v[168:171], v[204:207], v[240:243], 0
    v_mfma_f32_16x16x32_bf16 v[172:175], v[208:211], v[240:243], 0
    v_mfma_f32_16x16x32_bf16 v[176:179], v[212:215], v[240:243], 0
    v_mfma_f32_16x16x32_bf16 v[180:183], v[216:219], v[240:243], 0
.L22:
    s_waitcnt lgkmcnt(6)
    v_mfma_f32_16x16x32_bf16 v[80:83], v[188:191], v[56:59], v[80:83]
    ds_read_b64_tr_b16 v[204:205], v20 offset:8192
    ds_read_b64_tr_b16 v[206:207], v20 offset:12288
    v_mfma_f32_16x16x32_bf16 v[84:87], v[188:191], v[60:63], v[84:87]
    ds_read_b64_tr_b16 v[208:209], v21 offset:8192
    ds_read_b64_tr_b16 v[210:211], v21 offset:12288
    s_waitcnt lgkmcnt(8)
    v_mfma_f32_16x16x32_bf16 v[88:91], v[192:195], v[56:59], v[88:91]
    ds_read_b64_tr_b16 v[212:213], v22 offset:8192
    ds_read_b64_tr_b16 v[214:215], v22 offset:12288
    v_mfma_f32_16x16x32_bf16 v[92:95], v[192:195], v[60:63], v[92:95]
    ds_read_b64_tr_b16 v[216:217], v23 offset:8192
    ds_read_b64_tr_b16 v[218:219], v23 offset:12288
    s_waitcnt lgkmcnt(10)
    v_mfma_f32_16x16x32_bf16 v[96:99], v[196:199], v[56:59], v[96:99]
    v_mfma_f32_16x16x32_bf16 v[100:103], v[196:199], v[60:63], v[100:103]
    s_waitcnt lgkmcnt(8)
    v_mfma_f32_16x16x32_bf16 v[104:107], v[200:203], v[56:59], v[104:107]
    v_mfma_f32_16x16x32_bf16 v[108:111], v[200:203], v[60:63], v[108:111]
    v_mfma_f32_16x16x32_bf16 v[144:147], v[28:31], v[56:59], v[144:147]
    s_cmp_eq_u32 s45, 1
    s_cbranch_scc0 .L23
    v_mfma_f32_16x16x32_bf16 v[152:155], v[188:191], v[244:247], v[152:155]
    v_mfma_f32_16x16x32_bf16 v[156:159], v[192:195], v[244:247], v[156:159]
    v_mfma_f32_16x16x32_bf16 v[160:163], v[196:199], v[244:247], v[160:163]
    v_mfma_f32_16x16x32_bf16 v[164:167], v[200:203], v[244:247], v[164:167]
    v_mfma_f32_16x16x32_bf16 v[184:187], v[28:31], v[244:247], v[184:187]
.L23:
    s_waitcnt lgkmcnt(0)
    s_barrier
    v_add_u32 v16, 100352, v8
    v_add_u32 v17, 100352, v9
    v_add_u32 v18, 100352, v10
    v_add_u32 v19, 100352, v11
    v_add_u32 v20, 100352, v12
    v_add_u32 v21, 100352, v13
    v_add_u32 v22, 100352, v14
    v_add_u32 v23, 100352, v15
    v_mfma_f32_16x16x32_bf16 v[112:115], v[204:207], v[56:59], v[112:115]
    ds_read_b64_tr_b16 v[188:189], v16 offset:0
    ds_read_b64_tr_b16 v[190:191], v16 offset:4096
    v_mfma_f32_16x16x32_bf16 v[116:119], v[204:207], v[60:63], v[116:119]
    ds_read_b64_tr_b16 v[192:193], v17 offset:0
    ds_read_b64_tr_b16 v[194:195], v17 offset:4096
    v_mfma_f32_16x16x32_bf16 v[120:123], v[208:211], v[56:59], v[120:123]
    ds_read_b64_tr_b16 v[196:197], v18 offset:0
    ds_read_b64_tr_b16 v[198:199], v18 offset:4096
    v_mfma_f32_16x16x32_bf16 v[124:127], v[208:211], v[60:63], v[124:127]
    ds_read_b64_tr_b16 v[200:201], v19 offset:0
    ds_read_b64_tr_b16 v[202:203], v19 offset:4096
    v_mfma_f32_16x16x32_bf16 v[128:131], v[212:215], v[56:59], v[128:131]
    v_mfma_f32_16x16x32_bf16 v[132:135], v[212:215], v[60:63], v[132:135]
    v_mfma_f32_16x16x32_bf16 v[136:139], v[216:219], v[56:59], v[136:139]
    v_mfma_f32_16x16x32_bf16 v[140:143], v[216:219], v[60:63], v[140:143]
    v_mfma_f32_16x16x32_bf16 v[148:151], v[28:31], v[60:63], v[148:151]
    s_cmp_eq_u32 s45, 1
    s_cbranch_scc0 .L24
    v_mfma_f32_16x16x32_bf16 v[168:171], v[204:207], v[244:247], v[168:171]
    v_mfma_f32_16x16x32_bf16 v[172:175], v[208:211], v[244:247], v[172:175]
    v_mfma_f32_16x16x32_bf16 v[176:179], v[212:215], v[244:247], v[176:179]
    v_mfma_f32_16x16x32_bf16 v[180:183], v[216:219], v[244:247], v[180:183]
.L24:
    s_waitcnt lgkmcnt(6)
    v_mfma_f32_16x16x32_bf16 v[80:83], v[188:191], v[64:67], v[80:83]
    ds_read_b64_tr_b16 v[204:205], v20 offset:0
    ds_read_b64_tr_b16 v[206:207], v20 offset:4096
    v_mfma_f32_16x16x32_bf16 v[84:87], v[188:191], v[68:71], v[84:87]
    ds_read_b64_tr_b16 v[208:209], v21 offset:0
    ds_read_b64_tr_b16 v[210:211], v21 offset:4096
    s_waitcnt lgkmcnt(8)
    v_mfma_f32_16x16x32_bf16 v[88:91], v[192:195], v[64:67], v[88:91]
    ds_read_b64_tr_b16 v[212:213], v22 offset:0
    ds_read_b64_tr_b16 v[214:215], v22 offset:4096
    v_mfma_f32_16x16x32_bf16 v[92:95], v[192:195], v[68:71], v[92:95]
    ds_read_b64_tr_b16 v[216:217], v23 offset:0
    ds_read_b64_tr_b16 v[218:219], v23 offset:4096
    s_waitcnt lgkmcnt(10)
    v_mfma_f32_16x16x32_bf16 v[96:99], v[196:199], v[64:67], v[96:99]
    v_mfma_f32_16x16x32_bf16 v[100:103], v[196:199], v[68:71], v[100:103]
    s_waitcnt lgkmcnt(8)
    v_mfma_f32_16x16x32_bf16 v[104:107], v[200:203], v[64:67], v[104:107]
    v_mfma_f32_16x16x32_bf16 v[108:111], v[200:203], v[68:71], v[108:111]
    v_mfma_f32_16x16x32_bf16 v[144:147], v[28:31], v[64:67], v[144:147]
    s_cmp_eq_u32 s45, 2
    s_cbranch_scc0 .L25
    v_mfma_f32_16x16x32_bf16 v[152:155], v[188:191], v[240:243], 0
    v_mfma_f32_16x16x32_bf16 v[156:159], v[192:195], v[240:243], 0
    v_mfma_f32_16x16x32_bf16 v[160:163], v[196:199], v[240:243], 0
    v_mfma_f32_16x16x32_bf16 v[164:167], v[200:203], v[240:243], 0
    v_mfma_f32_16x16x32_bf16 v[184:187], v[28:31], v[240:243], 0
.L25:
    s_waitcnt lgkmcnt(6)
    v_mfma_f32_16x16x32_bf16 v[112:115], v[204:207], v[64:67], v[112:115]
    ds_read_b64_tr_b16 v[188:189], v16 offset:8192
    ds_read_b64_tr_b16 v[190:191], v16 offset:12288
    v_mfma_f32_16x16x32_bf16 v[116:119], v[204:207], v[68:71], v[116:119]
    ds_read_b64_tr_b16 v[192:193], v17 offset:8192
    ds_read_b64_tr_b16 v[194:195], v17 offset:12288
    s_waitcnt lgkmcnt(8)
    v_mfma_f32_16x16x32_bf16 v[120:123], v[208:211], v[64:67], v[120:123]
    ds_read_b64_tr_b16 v[196:197], v18 offset:8192
    ds_read_b64_tr_b16 v[198:199], v18 offset:12288
    v_mfma_f32_16x16x32_bf16 v[124:127], v[208:211], v[68:71], v[124:127]
    ds_read_b64_tr_b16 v[200:201], v19 offset:8192
    ds_read_b64_tr_b16 v[202:203], v19 offset:12288
    s_waitcnt lgkmcnt(10)
    v_mfma_f32_16x16x32_bf16 v[128:131], v[212:215], v[64:67], v[128:131]
    v_mfma_f32_16x16x32_bf16 v[132:135], v[212:215], v[68:71], v[132:135]
    s_waitcnt lgkmcnt(8)
    v_mfma_f32_16x16x32_bf16 v[136:139], v[216:219], v[64:67], v[136:139]
    v_mfma_f32_16x16x32_bf16 v[140:143], v[216:219], v[68:71], v[140:143]
    v_mfma_f32_16x16x32_bf16 v[148:151], v[28:31], v[68:71], v[148:151]
    s_cmp_eq_u32 s45, 2
    s_cbranch_scc0 .L26
    v_mfma_f32_16x16x32_bf16 v[168:171], v[204:207], v[240:243], 0
    v_mfma_f32_16x16x32_bf16 v[172:175], v[208:211], v[240:243], 0
    v_mfma_f32_16x16x32_bf16 v[176:179], v[212:215], v[240:243], 0
    v_mfma_f32_16x16x32_bf16 v[180:183], v[216:219], v[240:243], 0
.L26:
    s_waitcnt lgkmcnt(6)
    v_mfma_f32_16x16x32_bf16 v[80:83], v[188:191], v[72:75], v[80:83]
    ds_read_b64_tr_b16 v[204:205], v20 offset:8192
    ds_read_b64_tr_b16 v[206:207], v20 offset:12288
    v_mfma_f32_16x16x32_bf16 v[84:87], v[188:191], v[76:79], v[84:87]
    ds_read_b64_tr_b16 v[208:209], v21 offset:8192
    ds_read_b64_tr_b16 v[210:211], v21 offset:12288
    s_waitcnt lgkmcnt(8)
    v_mfma_f32_16x16x32_bf16 v[88:91], v[192:195], v[72:75], v[88:91]
    ds_read_b64_tr_b16 v[212:213], v22 offset:8192
    ds_read_b64_tr_b16 v[214:215], v22 offset:12288
    v_mfma_f32_16x16x32_bf16 v[92:95], v[192:195], v[76:79], v[92:95]
    ds_read_b64_tr_b16 v[216:217], v23 offset:8192
    ds_read_b64_tr_b16 v[218:219], v23 offset:12288
    s_waitcnt lgkmcnt(10)
    v_mfma_f32_16x16x32_bf16 v[96:99], v[196:199], v[72:75], v[96:99]
    v_mfma_f32_16x16x32_bf16 v[100:103], v[196:199], v[76:79], v[100:103]
    s_waitcnt lgkmcnt(8)
    v_mfma_f32_16x16x32_bf16 v[104:107], v[200:203], v[72:75], v[104:107]
    v_mfma_f32_16x16x32_bf16 v[108:111], v[200:203], v[76:79], v[108:111]
    v_mfma_f32_16x16x32_bf16 v[144:147], v[28:31], v[72:75], v[144:147]
    s_cmp_eq_u32 s45, 2
    s_cbranch_scc0 .L27
    v_mfma_f32_16x16x32_bf16 v[152:155], v[188:191], v[244:247], v[152:155]
    v_mfma_f32_16x16x32_bf16 v[156:159], v[192:195], v[244:247], v[156:159]
    v_mfma_f32_16x16x32_bf16 v[160:163], v[196:199], v[244:247], v[160:163]
    v_mfma_f32_16x16x32_bf16 v[164:167], v[200:203], v[244:247], v[164:167]
    v_mfma_f32_16x16x32_bf16 v[184:187], v[28:31], v[244:247], v[184:187]
.L27:
    s_waitcnt lgkmcnt(0)
    s_barrier
    v_add_u32 v16, 16384, v8
    v_add_u32 v17, 16384, v9
    v_add_u32 v18, 16384, v10
    v_add_u32 v19, 16384, v11
    v_add_u32 v20, 16384, v12
    v_add_u32 v21, 16384, v13
    v_add_u32 v22, 16384, v14
    v_add_u32 v23, 16384, v15
    v_mfma_f32_16x16x32_bf16 v[112:115], v[204:207], v[72:75], v[112:115]
    ds_read_b64_tr_b16 v[188:189], v16 offset:0
    ds_read_b64_tr_b16 v[190:191], v16 offset:4096
    v_mfma_f32_16x16x32_bf16 v[116:119], v[204:207], v[76:79], v[116:119]
    ds_read_b64_tr_b16 v[192:193], v17 offset:0
    ds_read_b64_tr_b16 v[194:195], v17 offset:4096
    v_mfma_f32_16x16x32_bf16 v[120:123], v[208:211], v[72:75], v[120:123]
    ds_read_b64_tr_b16 v[196:197], v18 offset:0
    ds_read_b64_tr_b16 v[198:199], v18 offset:4096
    v_mfma_f32_16x16x32_bf16 v[124:127], v[208:211], v[76:79], v[124:127]
    ds_read_b64_tr_b16 v[200:201], v19 offset:0
    ds_read_b64_tr_b16 v[202:203], v19 offset:4096
    v_mfma_f32_16x16x32_bf16 v[128:131], v[212:215], v[72:75], v[128:131]
    v_mfma_f32_16x16x32_bf16 v[132:135], v[212:215], v[76:79], v[132:135]
    v_mfma_f32_16x16x32_bf16 v[136:139], v[216:219], v[72:75], v[136:139]
    v_mfma_f32_16x16x32_bf16 v[140:143], v[216:219], v[76:79], v[140:143]
    v_mfma_f32_16x16x32_bf16 v[148:151], v[28:31], v[76:79], v[148:151]
    s_cmp_eq_u32 s45, 2
    s_cbranch_scc0 .L28
    v_mfma_f32_16x16x32_bf16 v[168:171], v[204:207], v[244:247], v[168:171]
    v_mfma_f32_16x16x32_bf16 v[172:175], v[208:211], v[244:247], v[172:175]
    v_mfma_f32_16x16x32_bf16 v[176:179], v[212:215], v[244:247], v[176:179]
    v_mfma_f32_16x16x32_bf16 v[180:183], v[216:219], v[244:247], v[180:183]
.L28:
    s_waitcnt lgkmcnt(6)
    v_mfma_f32_16x16x32_bf16 v[80:83], v[188:191], v[224:227], v[80:83]
    ds_read_b64_tr_b16 v[204:205], v20 offset:0
    ds_read_b64_tr_b16 v[206:207], v20 offset:4096
    v_mfma_f32_16x16x32_bf16 v[84:87], v[188:191], v[228:231], v[84:87]
    ds_read_b64_tr_b16 v[208:209], v21 offset:0
    ds_read_b64_tr_b16 v[210:211], v21 offset:4096
    s_waitcnt lgkmcnt(8)
    v_mfma_f32_16x16x32_bf16 v[88:91], v[192:195], v[224:227], v[88:91]
    ds_read_b64_tr_b16 v[212:213], v22 offset:0
    ds_read_b64_tr_b16 v[214:215], v22 offset:4096
    v_mfma_f32_16x16x32_bf16 v[92:95], v[192:195], v[228:231], v[92:95]
    ds_read_b64_tr_b16 v[216:217], v23 offset:0
    ds_read_b64_tr_b16 v[218:219], v23 offset:4096
    s_waitcnt lgkmcnt(10)
    v_mfma_f32_16x16x32_bf16 v[96:99], v[196:199], v[224:227], v[96:99]
    v_mfma_f32_16x16x32_bf16 v[100:103], v[196:199], v[228:231], v[100:103]
    s_waitcnt lgkmcnt(8)
    v_mfma_f32_16x16x32_bf16 v[104:107], v[200:203], v[224:227], v[104:107]
    v_mfma_f32_16x16x32_bf16 v[108:111], v[200:203], v[228:231], v[108:111]
    v_mfma_f32_16x16x32_bf16 v[144:147], v[28:31], v[224:227], v[144:147]
    s_cmp_eq_u32 s45, 3
    s_cbranch_scc0 .L29
    v_mfma_f32_16x16x32_bf16 v[152:155], v[188:191], v[240:243], 0
    v_mfma_f32_16x16x32_bf16 v[156:159], v[192:195], v[240:243], 0
    v_mfma_f32_16x16x32_bf16 v[160:163], v[196:199], v[240:243], 0
    v_mfma_f32_16x16x32_bf16 v[164:167], v[200:203], v[240:243], 0
    v_mfma_f32_16x16x32_bf16 v[184:187], v[28:31], v[240:243], 0
.L29:
    s_waitcnt lgkmcnt(6)
    v_mfma_f32_16x16x32_bf16 v[112:115], v[204:207], v[224:227], v[112:115]
    ds_read_b64_tr_b16 v[188:189], v16 offset:8192
    ds_read_b64_tr_b16 v[190:191], v16 offset:12288
    v_mfma_f32_16x16x32_bf16 v[116:119], v[204:207], v[228:231], v[116:119]
    ds_read_b64_tr_b16 v[192:193], v17 offset:8192
    ds_read_b64_tr_b16 v[194:195], v17 offset:12288
    s_waitcnt lgkmcnt(8)
    v_mfma_f32_16x16x32_bf16 v[120:123], v[208:211], v[224:227], v[120:123]
    ds_read_b64_tr_b16 v[196:197], v18 offset:8192
    ds_read_b64_tr_b16 v[198:199], v18 offset:12288
    v_mfma_f32_16x16x32_bf16 v[124:127], v[208:211], v[228:231], v[124:127]
    ds_read_b64_tr_b16 v[200:201], v19 offset:8192
    ds_read_b64_tr_b16 v[202:203], v19 offset:12288
    s_waitcnt lgkmcnt(10)
    v_mfma_f32_16x16x32_bf16 v[128:131], v[212:215], v[224:227], v[128:131]
    v_mfma_f32_16x16x32_bf16 v[132:135], v[212:215], v[228:231], v[132:135]
    s_waitcnt lgkmcnt(8)
    v_mfma_f32_16x16x32_bf16 v[136:139], v[216:219], v[224:227], v[136:139]
    v_mfma_f32_16x16x32_bf16 v[140:143], v[216:219], v[228:231], v[140:143]
    v_mfma_f32_16x16x32_bf16 v[148:151], v[28:31], v[228:231], v[148:151]
    s_cmp_eq_u32 s45, 3
    s_cbranch_scc0 .L30
    v_mfma_f32_16x16x32_bf16 v[168:171], v[204:207], v[240:243], 0
    v_mfma_f32_16x16x32_bf16 v[172:175], v[208:211], v[240:243], 0
    v_mfma_f32_16x16x32_bf16 v[176:179], v[212:215], v[240:243], 0
    v_mfma_f32_16x16x32_bf16 v[180:183], v[216:219], v[240:243], 0
.L30:
    s_waitcnt lgkmcnt(6)
    v_mfma_f32_16x16x32_bf16 v[80:83], v[188:191], v[232:235], v[80:83]
    ds_read_b64_tr_b16 v[204:205], v20 offset:8192
    ds_read_b64_tr_b16 v[206:207], v20 offset:12288
    v_mfma_f32_16x16x32_bf16 v[84:87], v[188:191], v[236:239], v[84:87]
    ds_read_b64_tr_b16 v[208:209], v21 offset:8192
    ds_read_b64_tr_b16 v[210:211], v21 offset:12288
    s_waitcnt lgkmcnt(8)
    v_mfma_f32_16x16x32_bf16 v[88:91], v[192:195], v[232:235], v[88:91]
    ds_read_b64_tr_b16 v[212:213], v22 offset:8192
    ds_read_b64_tr_b16 v[214:215], v22 offset:12288
    v_mfma_f32_16x16x32_bf16 v[92:95], v[192:195], v[236:239], v[92:95]
    ds_read_b64_tr_b16 v[216:217], v23 offset:8192
    ds_read_b64_tr_b16 v[218:219], v23 offset:12288
    s_waitcnt lgkmcnt(10)
    v_mfma_f32_16x16x32_bf16 v[96:99], v[196:199], v[232:235], v[96:99]
    v_mfma_f32_16x16x32_bf16 v[100:103], v[196:199], v[236:239], v[100:103]
    s_waitcnt lgkmcnt(8)
    v_mfma_f32_16x16x32_bf16 v[104:107], v[200:203], v[232:235], v[104:107]
    v_mfma_f32_16x16x32_bf16 v[108:111], v[200:203], v[236:239], v[108:111]
    v_mfma_f32_16x16x32_bf16 v[144:147], v[28:31], v[232:235], v[144:147]
    s_cmp_eq_u32 s45, 3
    s_cbranch_scc0 .L31
    v_mfma_f32_16x16x32_bf16 v[152:155], v[188:191], v[244:247], v[152:155]
    v_mfma_f32_16x16x32_bf16 v[156:159], v[192:195], v[244:247], v[156:159]
    v_mfma_f32_16x16x32_bf16 v[160:163], v[196:199], v[244:247], v[160:163]
    v_mfma_f32_16x16x32_bf16 v[164:167], v[200:203], v[244:247], v[164:167]
    v_mfma_f32_16x16x32_bf16 v[184:187], v[28:31], v[244:247], v[184:187]
.L31:
    s_waitcnt lgkmcnt(6)
    v_mfma_f32_16x16x32_bf16 v[112:115], v[204:207], v[232:235], v[112:115]
    v_mfma_f32_16x16x32_bf16 v[116:119], v[204:207], v[236:239], v[116:119]
    s_waitcnt lgkmcnt(4)
    v_mfma_f32_16x16x32_bf16 v[120:123], v[208:211], v[232:235], v[120:123]
    v_mfma_f32_16x16x32_bf16 v[124:127], v[208:211], v[236:239], v[124:127]
    s_waitcnt lgkmcnt(2)
    v_mfma_f32_16x16x32_bf16 v[128:131], v[212:215], v[232:235], v[128:131]
    v_mfma_f32_16x16x32_bf16 v[132:135], v[212:215], v[236:239], v[132:135]
    s_waitcnt lgkmcnt(0)
    v_mfma_f32_16x16x32_bf16 v[136:139], v[216:219], v[232:235], v[136:139]
    v_mfma_f32_16x16x32_bf16 v[140:143], v[216:219], v[236:239], v[140:143]
    v_mfma_f32_16x16x32_bf16 v[148:151], v[28:31], v[236:239], v[148:151]
    s_cmp_eq_u32 s45, 3
    s_cbranch_scc0 .L32
    v_mfma_f32_16x16x32_bf16 v[168:171], v[204:207], v[244:247], v[168:171]
    v_mfma_f32_16x16x32_bf16 v[172:175], v[208:211], v[244:247], v[172:175]
    v_mfma_f32_16x16x32_bf16 v[176:179], v[212:215], v[244:247], v[176:179]
    v_mfma_f32_16x16x32_bf16 v[180:183], v[216:219], v[244:247], v[180:183]
.L32:
    s_waitcnt lgkmcnt(0)
    s_barrier
    s_mul_i32 s47, s45, 9216
    s_add_u32 s47, s47, 0
    v_add_u32 v1, s47, v26
    v_lshlrev_b32 v2, 2, v0
    v_add_u32 v2, s47, v2
    s_mul_i32 s47, s45, 8704
    s_add_u32 s47, s47, 83968
    v_add_u32 v3, s47, v26
    v_lshlrev_b32 v4, 2, v0
    v_add_u32 v4, s47, v4
    ds_write_b128 v1, v[84:87] offset:0
    ds_write_b128 v1, v[92:95] offset:1024
    ds_write_b128 v1, v[100:103] offset:2048
    ds_write_b128 v1, v[108:111] offset:3072
    ds_write_b128 v1, v[116:119] offset:4096
    ds_write_b128 v1, v[124:127] offset:5120
    ds_write_b128 v1, v[132:135] offset:6144
    ds_write_b128 v1, v[140:143] offset:7168
    ds_write_b32 v2, v148 offset:8192
    ds_write_b32 v2, v250 offset:8448
    s_waitcnt lgkmcnt(4)
    ds_write_b128 v3, v[152:155] offset:0
    ds_write_b128 v3, v[156:159] offset:1024
    ds_write_b128 v3, v[160:163] offset:2048
    ds_write_b128 v3, v[164:167] offset:3072
    ds_write_b128 v3, v[168:171] offset:4096
    ds_write_b128 v3, v[172:175] offset:5120
    ds_write_b128 v3, v[176:179] offset:6144
    ds_write_b128 v3, v[180:183] offset:7168
    ds_write_b32 v4, v184 offset:8192
    ds_write_b32 v4, v252 offset:8448
    s_lshl_b32 s47, s2, 2
    s_add_u32 s47, s47, s45
    s_lshr_b32 s55, s47, 3
    s_and_b32 s56, s47, 7
    v_lshrrev_b32 v1, 4, v0
    v_mul_u32_u24 v6, 4608, v1
    v_lshl_add_u32 v6, v27, 2, v6
    v_add_u32 v7, 18432, v6
    s_mov_b32 s58, 0x05040100
    s_mov_b32 s59, 0x07060302
    s_mul_i32 s49, s55, 36864
    s_lshl_b32 s48, s56, 6
    s_add_u32 s49, s49, s48
    s_cmp_lt_u32 s56, 2
    s_cselect_b32 s54, 16, 8
    s_add_u32 s47, s49, 0
    buffer_load_dword v188, v6, s[36:39], s47 offen offset:0
    buffer_load_dword v189, v6, s[36:39], s47 offen offset:1152
    buffer_load_dword v190, v6, s[36:39], s47 offen offset:2304
    buffer_load_dword v191, v6, s[36:39], s47 offen offset:3456
    buffer_load_dword v192, v7, s[36:39], s47 offen offset:0
    buffer_load_dword v193, v7, s[36:39], s47 offen offset:1152
    buffer_load_dword v194, v7, s[36:39], s47 offen offset:2304
    buffer_load_dword v195, v7, s[36:39], s47 offen offset:3456
    s_waitcnt lgkmcnt(0)
    s_barrier
    s_add_u32 s47, s49, 512
    buffer_load_dword v196, v6, s[36:39], s47 offen offset:0
    buffer_load_dword v197, v6, s[36:39], s47 offen offset:1152
    buffer_load_dword v198, v6, s[36:39], s47 offen offset:2304
    buffer_load_dword v199, v6, s[36:39], s47 offen offset:3456
    buffer_load_dword v200, v7, s[36:39], s47 offen offset:0
    buffer_load_dword v201, v7, s[36:39], s47 offen offset:1152
    buffer_load_dword v202, v7, s[36:39], s47 offen offset:2304
    buffer_load_dword v203, v7, s[36:39], s47 offen offset:3456
    s_barrier
    s_lshl_b32 s47, s54, 6
    s_add_u32 s47, s47, s49
    buffer_load_dword v204, v6, s[36:39], s47 offen offset:0
    buffer_load_dword v205, v6, s[36:39], s47 offen offset:1152
    buffer_load_dword v206, v6, s[36:39], s47 offen offset:2304
    buffer_load_dword v207, v6, s[36:39], s47 offen offset:3456
    buffer_load_dword v208, v7, s[36:39], s47 offen offset:0
    buffer_load_dword v209, v7, s[36:39], s47 offen offset:1152
    buffer_load_dword v210, v7, s[36:39], s47 offen offset:2304
    buffer_load_dword v211, v7, s[36:39], s47 offen offset:3456
    s_barrier
    s_barrier
    s_waitcnt vmcnt(16)
    v_perm_b32 v220, v189, v188, s58
    v_perm_b32 v224, v189, v188, s59
    v_perm_b32 v221, v191, v190, s58
    v_perm_b32 v225, v191, v190, s59
    v_perm_b32 v222, v193, v192, s58
    v_perm_b32 v226, v193, v192, s59
    v_perm_b32 v223, v195, v194, s58
    v_perm_b32 v227, v195, v194, s59
    s_add_u32 s47, s56, 0
    s_lshl_b32 s47, s47, 8
    s_add_u32 s47, s47, s55
    s_lshl_b32 s47, s47, 10
    s_add_u32 s47, s47, 16777216
    s_add_u32 s48, s47, 131072
    buffer_store_dwordx4 v[220:223], v26, s[40:43], s47 offen sc0 sc1
    buffer_store_dwordx4 v[224:227], v26, s[40:43], s48 offen sc0 sc1
    s_nop 1
    s_waitcnt vmcnt(10)
    v_perm_b32 v220, v197, v196, s58
    v_perm_b32 v224, v197, v196, s59
    v_perm_b32 v221, v199, v198, s58
    v_perm_b32 v225, v199, v198, s59
    v_perm_b32 v222, v201, v200, s58
    v_perm_b32 v226, v201, v200, s59
    v_perm_b32 v223, v203, v202, s58
    v_perm_b32 v227, v203, v202, s59
    s_add_u32 s47, s56, 8
    s_lshl_b32 s47, s47, 8
    s_add_u32 s47, s47, s55
    s_lshl_b32 s47, s47, 10
    s_add_u32 s47, s47, 16777216
    s_add_u32 s48, s47, 131072
    buffer_store_dwordx4 v[220:223], v26, s[40:43], s47 offen sc0 sc1
    buffer_store_dwordx4 v[224:227], v26, s[40:43], s48 offen sc0 sc1
    s_nop 1
    s_waitcnt vmcnt(4)
    v_perm_b32 v220, v205, v204, s58
    v_perm_b32 v224, v205, v204, s59
    v_perm_b32 v221, v207, v206, s58
    v_perm_b32 v225, v207, v206, s59
    v_perm_b32 v222, v209, v208, s58
    v_perm_b32 v226, v209, v208, s59
    v_perm_b32 v223, v211, v210, s58
    v_perm_b32 v227, v211, v210, s59
    s_add_u32 s47, s56, s54
    s_lshl_b32 s47, s47, 8
    s_add_u32 s47, s47, s55
    s_lshl_b32 s47, s47, 10
    s_add_u32 s47, s47, 16777216
    s_add_u32 s48, s47, 131072
    buffer_store_dwordx4 v[220:223], v26, s[40:43], s47 offen sc0 sc1
    buffer_store_dwordx4 v[224:227], v26, s[40:43], s48 offen sc0 sc1
    s_nop 1
    s_barrier
    s_barrier
    s_waitcnt lgkmcnt(0)
    s_barrier
    s_mul_i32 s48, s45, 9216
    s_add_u32 s48, s48, 118784
    v_add_u32 v1, s48, v26
    v_lshlrev_b32 v2, 2, v0
    v_add_u32 v2, s48, v2
    ds_read_b32 v8, v2 offset:8192
    ds_read_b32 v10, v2 offset:8448
    ds_read_b128 v[32:35], v1 offset:0
    ds_read_b128 v[36:39], v1 offset:1024
    ds_read_b128 v[40:43], v1 offset:2048
    ds_read_b128 v[44:47], v1 offset:3072
    ds_read_b128 v[48:51], v1 offset:4096
    ds_read_b128 v[52:55], v1 offset:5120
    ds_read_b128 v[56:59], v1 offset:6144
    ds_read_b128 v[60:63], v1 offset:7168
    s_mul_i32 s47, s51, 9
    s_lshl_b32 s57, s52, 2
    s_lshl_b32 s48, s45, 1
    s_add_u32 s48, s48, 0
    s_add_u32 s48, s48, s47
    s_lshl_b32 s48, s48, 7
    s_add_u32 s48, s48, s57
    s_lshl_b32 s48, s48, 10
    s_waitcnt lgkmcnt(8)
    v_min_f32 v12, v10, v248
    v_sub_f32 v10, v12, v10
    v_sub_f32 v13, v12, v248
    v_exp_f32 v10, v10
    v_exp_f32 v13, v13
    s_nop 0
    v_mul_f32 v8, v8, v10
    v_fmac_f32 v8, v13, v144
    v_rcp_f32 v8, v8
    s_nop 0
    v_mul_f32 v10, v10, v8
    v_mul_f32 v8, v13, v8
    s_waitcnt lgkmcnt(6)
    v_mul_f32 v32, v32, v10
    v_mul_f32 v33, v33, v10
    v_mul_f32 v34, v34, v10
    v_mul_f32 v35, v35, v10
    v_fmac_f32 v32, v80, v8
    v_fmac_f32 v33, v81, v8
    v_fmac_f32 v34, v82, v8
    v_fmac_f32 v35, v83, v8
    v_mul_f32 v36, v36, v10
    v_mul_f32 v37, v37, v10
    v_mul_f32 v38, v38, v10
    v_mul_f32 v39, v39, v10
    v_fmac_f32 v36, v88, v8
    v_fmac_f32 v37, v89, v8
    v_fmac_f32 v38, v90, v8
    v_fmac_f32 v39, v91, v8
    v_cvt_pk_bf16_f32 v64, v32, v33
    v_cvt_pk_bf16_f32 v65, v34, v35
    v_cvt_pk_bf16_f32 v66, v36, v37
    v_cvt_pk_bf16_f32 v67, v38, v39
    buffer_store_dwordx4 v[64:67], v26, s[40:43], s48 offen offset:0 sc0 sc1
    s_waitcnt lgkmcnt(4)
    v_mul_f32 v40, v40, v10
    v_mul_f32 v41, v41, v10
    v_mul_f32 v42, v42, v10
    v_mul_f32 v43, v43, v10
    v_fmac_f32 v40, v96, v8
    v_fmac_f32 v41, v97, v8
    v_fmac_f32 v42, v98, v8
    v_fmac_f32 v43, v99, v8
    v_mul_f32 v44, v44, v10
    v_mul_f32 v45, v45, v10
    v_mul_f32 v46, v46, v10
    v_mul_f32 v47, v47, v10
    v_fmac_f32 v44, v104, v8
    v_fmac_f32 v45, v105, v8
    v_fmac_f32 v46, v106, v8
    v_fmac_f32 v47, v107, v8
    v_cvt_pk_bf16_f32 v68, v40, v41
    v_cvt_pk_bf16_f32 v69, v42, v43
    v_cvt_pk_bf16_f32 v70, v44, v45
    v_cvt_pk_bf16_f32 v71, v46, v47
    buffer_store_dwordx4 v[68:71], v26, s[40:43], s48 offen offset:1024 sc0 sc1
    s_waitcnt lgkmcnt(2)
    v_mul_f32 v48, v48, v10
    v_mul_f32 v49, v49, v10
    v_mul_f32 v50, v50, v10
    v_mul_f32 v51, v51, v10
    v_fmac_f32 v48, v112, v8
    v_fmac_f32 v49, v113, v8
    v_fmac_f32 v50, v114, v8
    v_fmac_f32 v51, v115, v8
    v_mul_f32 v52, v52, v10
    v_mul_f32 v53, v53, v10
    v_mul_f32 v54, v54, v10
    v_mul_f32 v55, v55, v10
    v_fmac_f32 v52, v120, v8
    v_fmac_f32 v53, v121, v8
    v_fmac_f32 v54, v122, v8
    v_fmac_f32 v55, v123, v8
    v_cvt_pk_bf16_f32 v72, v48, v49
    v_cvt_pk_bf16_f32 v73, v50, v51
    v_cvt_pk_bf16_f32 v74, v52, v53
    v_cvt_pk_bf16_f32 v75, v54, v55
    buffer_store_dwordx4 v[72:75], v26, s[40:43], s48 offen offset:2048 sc0 sc1
    s_waitcnt lgkmcnt(0)
    v_mul_f32 v56, v56, v10
    v_mul_f32 v57, v57, v10
    v_mul_f32 v58, v58, v10
    v_mul_f32 v59, v59, v10
    v_fmac_f32 v56, v128, v8
    v_fmac_f32 v57, v129, v8
    v_fmac_f32 v58, v130, v8
    v_fmac_f32 v59, v131, v8
    v_mul_f32 v60, v60, v10
    v_mul_f32 v61, v61, v10
    v_mul_f32 v62, v62, v10
    v_mul_f32 v63, v63, v10
    v_fmac_f32 v60, v136, v8
    v_fmac_f32 v61, v137, v8
    v_fmac_f32 v62, v138, v8
    v_fmac_f32 v63, v139, v8
    v_cvt_pk_bf16_f32 v76, v56, v57
    v_cvt_pk_bf16_f32 v77, v58, v59
    v_cvt_pk_bf16_f32 v78, v60, v61
    v_cvt_pk_bf16_f32 v79, v62, v63
    buffer_store_dwordx4 v[76:79], v26, s[40:43], s48 offen offset:3072 sc0 sc1
    s_endpgm
.Lk1_B:
    s_lshl_b32 s47, s45, 4
    v_add_u32 v1, 0, v28
    v_xor_b32 v2, v1, v27
    v_add_u32 v1, s47, v1
    v_lshlrev_b32 v1, 8, v1
    v_lshl_add_u32 v2, v2, 4, v1
    v_add_u32 v1, 4, v28
    v_xor_b32 v3, v1, v27
    v_add_u32 v1, s47, v1
    v_lshlrev_b32 v1, 8, v1
    v_lshl_add_u32 v3, v3, 4, v1
    v_add_u32 v1, 8, v28
    v_xor_b32 v4, v1, v27
    v_add_u32 v1, s47, v1
    v_lshlrev_b32 v1, 8, v1
    v_lshl_add_u32 v4, v4, 4, v1
    v_add_u32 v1, 12, v28
    v_xor_b32 v5, v1, v27
    v_add_u32 v1, s47, v1
    v_lshlrev_b32 v1, 8, v1
    v_lshl_add_u32 v5, v5, 4, v1
    v_add_u32 v1, 0, v28
    v_lshlrev_b32 v6, 1, v1
    v_xor_b32 v6, v6, v27
    v_add_u32 v1, s47, v1
    v_lshlrev_b32 v1, 8, v1
    v_lshl_add_u32 v6, v6, 4, v1
    v_add_u32 v1, 4, v28
    v_lshlrev_b32 v7, 1, v1
    v_xor_b32 v7, v7, v27
    v_add_u32 v1, s47, v1
    v_lshlrev_b32 v1, 8, v1
    v_lshl_add_u32 v7, v7, 4, v1
    s_lshl_b32 s47, s44, 8
    v_lshl_add_u32 v1, v0, 2, s47
    v_mov_b32 v8, 0xff800000
    v_add_u32 v1, 161792, v1
    ds_write_b32 v1, v8
    v_and_b32 v1, 1, v28
    v_lshl_add_u32 v31, v1, 2, v29
    v_lshl_add_u32 v1, v28, 3, v29
    v_lshlrev_b32 v1, 8, v1
    v_lshl_add_u32 v1, v30, 3, v1
    v_xor_b32 v8, 4, v31
    v_lshl_add_u32 v8, v8, 5, v1
    v_xor_b32 v9, 5, v31
    v_lshl_add_u32 v9, v9, 5, v1
    v_xor_b32 v10, 6, v31
    v_lshl_add_u32 v10, v10, 5, v1
    v_xor_b32 v11, 7, v31
    v_lshl_add_u32 v11, v11, 5, v1
    v_xor_b32 v12, s44, v31
    v_lshl_add_u32 v12, v12, 5, v1
    v_bfe_u32 v1, v27, 1, 2
    v_lshrrev_b32 v13, 3, v27
    v_lshl_add_u32 v1, v13, 2, v1
    v_xor_b32 v1, v1, v28
    v_lshlrev_b32 v1, 4, v1
    v_lshl_add_u32 v1, v13, 10, v1
    v_and_b32 v13, 7, v27
    v_lshl_add_u32 v1, v13, 7, v1
    v_add_u32 v15, 32768, v1
    v_xor_b32 v24, 64, v15
    s_lshl_b32 s47, s45, 12
    s_add_u32 s47, s47, 16384
    v_add_u32 v13, s47, v1
    v_xor_b32 v14, 64, v13
    s_barrier
    v_add_u32 v16, 49152, v8
    v_add_u32 v17, 49152, v9
    v_add_u32 v18, 49152, v10
    v_add_u32 v19, 49152, v11
    v_add_u32 v20, 49152, v12
    v_add_u32 v21, 49152, v13
    v_add_u32 v22, 49152, v14
    v_add_u32 v23, 49152, v15
    v_add_u32 v25, 49152, v24
    ds_read_b128 v[92:95], v21
    ds_read_b128 v[96:99], v21 offset:2048
    ds_read_b64_tr_b16 v[72:73], v16 offset:0
    ds_read_b64_tr_b16 v[74:75], v16 offset:1024
    ds_read_b64_tr_b16 v[76:77], v17 offset:0
    ds_read_b64_tr_b16 v[78:79], v17 offset:1024
    ds_read_b64_tr_b16 v[80:81], v18 offset:0
    ds_read_b64_tr_b16 v[82:83], v18 offset:1024
    ds_read_b64_tr_b16 v[84:85], v19 offset:0
    ds_read_b64_tr_b16 v[86:87], v19 offset:1024
    ds_read_b64_tr_b16 v[88:89], v20 offset:0
    ds_read_b64_tr_b16 v[90:91], v20 offset:1024
    ds_read_b128 v[100:103], v23
    s_waitcnt lgkmcnt(9)
    v_mfma_f32_16x16x32_bf16 v[32:35], v[72:75], v[92:95], 0
    ds_read_b128 v[124:127], v22
    ds_read_b128 v[128:131], v22 offset:2048
    ds_read_b64_tr_b16 v[104:105], v16 offset:8192
    v_mfma_f32_16x16x32_bf16 v[36:39], v[72:75], v[96:99], 0
    ds_read_b64_tr_b16 v[106:107], v16 offset:9216
    ds_read_b64_tr_b16 v[108:109], v17 offset:8192
    s_waitcnt lgkmcnt(12)
    v_mfma_f32_16x16x32_bf16 v[40:43], v[76:79], v[92:95], 0
    ds_read_b64_tr_b16 v[110:111], v17 offset:9216
    ds_read_b64_tr_b16 v[112:113], v18 offset:8192
    v_mfma_f32_16x16x32_bf16 v[44:47], v[76:79], v[96:99], 0
    s_waitcnt lgkmcnt(12)
    v_mfma_f32_16x16x32_bf16 v[48:51], v[80:83], v[92:95], 0
    ds_read_b64_tr_b16 v[114:115], v18 offset:9216
    ds_read_b64_tr_b16 v[116:117], v19 offset:8192
    v_mfma_f32_16x16x32_bf16 v[52:55], v[80:83], v[96:99], 0
    s_waitcnt lgkmcnt(12)
    v_mfma_f32_16x16x32_bf16 v[56:59], v[84:87], v[92:95], 0
    ds_read_b64_tr_b16 v[118:119], v19 offset:9216
    ds_read_b64_tr_b16 v[120:121], v20 offset:8192
    v_mfma_f32_16x16x32_bf16 v[60:63], v[84:87], v[96:99], 0
    s_waitcnt lgkmcnt(11)
    v_mfma_f32_16x16x32_bf16 v[64:67], v[88:91], v[100:103], 0
    ds_read_b64_tr_b16 v[122:123], v20 offset:9216
    ds_read_b128 v[132:135], v25
    s_add_u32 m0, s46, 0
    s_mov_b32 s57, 0
    buffer_load_dwordx4 v2, s[24:27], s57 offen nt lds
    s_waitcnt lgkmcnt(0)
    s_add_u32 m0, s46, 1024
    s_mov_b32 s57, 0
    buffer_load_dwordx4 v3, s[24:27], s57 offen nt lds
    s_add_u32 m0, s46, 2048
    s_mov_b32 s57, 0
    buffer_load_dwordx4 v4, s[24:27], s57 offen nt lds
    s_add_u32 m0, s46, 3072
    s_mov_b32 s57, 0
    buffer_load_dwordx4 v5, s[24:27], s57 offen nt lds
    s_barrier
    v_add_u32 v16, 83968, v8
    v_add_u32 v17, 83968, v9
    v_add_u32 v18, 83968, v10
    v_add_u32 v19, 83968, v11
    v_add_u32 v20, 83968, v12
    v_add_u32 v21, 83968, v13
    v_add_u32 v22, 83968, v14
    v_add_u32 v23, 83968, v15
    v_add_u32 v25, 83968, v24
    v_mfma_f32_16x16x32_bf16 v[32:35], v[104:107], v[124:127], v[32:35]
    ds_read_b128 v[92:95], v21
    ds_read_b128 v[96:99], v21 offset:2048
    ds_read_b64_tr_b16 v[72:73], v16 offset:0
    v_mfma_f32_16x16x32_bf16 v[36:39], v[104:107], v[128:131], v[36:39]
    ds_read_b64_tr_b16 v[74:75], v16 offset:1024
    ds_read_b64_tr_b16 v[76:77], v17 offset:0
    ds_read_b64_tr_b16 v[78:79], v17 offset:1024
    v_mfma_f32_16x16x32_bf16 v[40:43], v[108:111], v[124:127], v[40:43]
    ds_read_b64_tr_b16 v[80:81], v18 offset:0
    ds_read_b64_tr_b16 v[82:83], v18 offset:1024
    ds_read_b64_tr_b16 v[84:85], v19 offset:0
    v_mfma_f32_16x16x32_bf16 v[44:47], v[108:111], v[128:131], v[44:47]
    ds_read_b64_tr_b16 v[86:87], v19 offset:1024
    ds_read_b64_tr_b16 v[88:89], v20 offset:0
    ds_read_b64_tr_b16 v[90:91], v20 offset:1024
    v_mfma_f32_16x16x32_bf16 v[48:51], v[112:115], v[124:127], v[48:51]
    ds_read_b128 v[100:103], v23
    s_add_u32 m0, s46, 16384
    s_mov_b32 s57, 16384
    buffer_load_dwordx4 v2, s[24:27], s57 offen nt lds
    v_mfma_f32_16x16x32_bf16 v[52:55], v[112:115], v[128:131], v[52:55]
    s_add_u32 m0, s46, 17408
    s_mov_b32 s57, 16384
    buffer_load_dwordx4 v3, s[24:27], s57 offen nt lds
    v_mfma_f32_16x16x32_bf16 v[56:59], v[116:119], v[124:127], v[56:59]
    s_add_u32 m0, s46, 18432
    s_mov_b32 s57, 16384
    buffer_load_dwordx4 v4, s[24:27], s57 offen nt lds
    v_mfma_f32_16x16x32_bf16 v[60:63], v[116:119], v[128:131], v[60:63]
    s_add_u32 m0, s46, 19456
    s_mov_b32 s57, 16384
    buffer_load_dwordx4 v5, s[24:27], s57 offen nt lds
    v_mfma_f32_16x16x32_bf16 v[64:67], v[120:123], v[132:135], v[64:67]
    s_waitcnt lgkmcnt(9)
    v_mfma_f32_16x16x32_bf16 v[32:35], v[72:75], v[92:95], v[32:35]
    ds_read_b128 v[124:127], v22
    ds_read_b128 v[128:131], v22 offset:2048
    ds_read_b64_tr_b16 v[104:105], v16 offset:8192
    v_mfma_f32_16x16x32_bf16 v[36:39], v[72:75], v[96:99], v[36:39]
    ds_read_b64_tr_b16 v[106:107], v16 offset:9216
    ds_read_b64_tr_b16 v[108:109], v17 offset:8192
    s_waitcnt lgkmcnt(12)
    v_mfma_f32_16x16x32_bf16 v[40:43], v[76:79], v[92:95], v[40:43]
    ds_read_b64_tr_b16 v[110:111], v17 offset:9216
    ds_read_b64_tr_b16 v[112:113], v18 offset:8192
    v_mfma_f32_16x16x32_bf16 v[44:47], v[76:79], v[96:99], v[44:47]
    s_waitcnt lgkmcnt(12)
    v_mfma_f32_16x16x32_bf16 v[48:51], v[80:83], v[92:95], v[48:51]
    ds_read_b64_tr_b16 v[114:115], v18 offset:9216
    ds_read_b64_tr_b16 v[116:117], v19 offset:8192
    v_mfma_f32_16x16x32_bf16 v[52:55], v[80:83], v[96:99], v[52:55]
    s_waitcnt lgkmcnt(12)
    v_mfma_f32_16x16x32_bf16 v[56:59], v[84:87], v[92:95], v[56:59]
    ds_read_b64_tr_b16 v[118:119], v19 offset:9216
    ds_read_b64_tr_b16 v[120:121], v20 offset:8192
    v_mfma_f32_16x16x32_bf16 v[60:63], v[84:87], v[96:99], v[60:63]
    s_waitcnt lgkmcnt(11)
    v_mfma_f32_16x16x32_bf16 v[64:67], v[88:91], v[100:103], v[64:67]
    ds_read_b64_tr_b16 v[122:123], v20 offset:9216
    ds_read_b128 v[132:135], v25
    s_waitcnt lgkmcnt(0)
    s_barrier
    v_add_u32 v16, 118784, v8
    v_add_u32 v17, 118784, v9
    v_add_u32 v18, 118784, v10
    v_add_u32 v19, 118784, v11
    v_add_u32 v20, 118784, v12
    v_add_u32 v21, 118784, v13
    v_add_u32 v22, 118784, v14
    v_add_u32 v23, 118784, v15
    v_add_u32 v25, 118784, v24
    v_mfma_f32_16x16x32_bf16 v[32:35], v[104:107], v[124:127], v[32:35]
    ds_read_b128 v[92:95], v21
    ds_read_b128 v[96:99], v21 offset:2048
    ds_read_b64_tr_b16 v[72:73], v16 offset:0
    v_mfma_f32_16x16x32_bf16 v[36:39], v[104:107], v[128:131], v[36:39]
    ds_read_b64_tr_b16 v[74:75], v16 offset:1024
    ds_read_b64_tr_b16 v[76:77], v17 offset:0
    ds_read_b64_tr_b16 v[78:79], v17 offset:1024
    v_mfma_f32_16x16x32_bf16 v[40:43], v[108:111], v[124:127], v[40:43]
    ds_read_b64_tr_b16 v[80:81], v18 offset:0
    ds_read_b64_tr_b16 v[82:83], v18 offset:1024
    ds_read_b64_tr_b16 v[84:85], v19 offset:0
    v_mfma_f32_16x16x32_bf16 v[44:47], v[108:111], v[128:131], v[44:47]
    ds_read_b64_tr_b16 v[86:87], v19 offset:1024
    ds_read_b64_tr_b16 v[88:89], v20 offset:0
    ds_read_b64_tr_b16 v[90:91], v20 offset:1024
    v_mfma_f32_16x16x32_bf16 v[48:51], v[112:115], v[124:127], v[48:51]
    ds_read_b128 v[100:103], v23
    s_add_u32 m0, s46, 32768
    s_mov_b32 s57, 32768
    buffer_load_dwordx4 v2, s[24:27], s57 offen nt lds
    v_mfma_f32_16x16x32_bf16 v[52:55], v[112:115], v[128:131], v[52:55]
    s_add_u32 m0, s46, 33792
    s_mov_b32 s57, 32768
    buffer_load_dwordx4 v3, s[24:27], s57 offen nt lds
    v_mfma_f32_16x16x32_bf16 v[56:59], v[116:119], v[124:127], v[56:59]
    s_add_u32 m0, s46, 34816
    s_mov_b32 s57, 32768
    buffer_load_dwordx4 v4, s[24:27], s57 offen nt lds
    v_mfma_f32_16x16x32_bf16 v[60:63], v[116:119], v[128:131], v[60:63]
    s_add_u32 m0, s46, 35840
    s_mov_b32 s57, 32768
    buffer_load_dwordx4 v5, s[24:27], s57 offen nt lds
    v_mfma_f32_16x16x32_bf16 v[64:67], v[120:123], v[132:135], v[64:67]
    s_waitcnt lgkmcnt(9)
    v_mfma_f32_16x16x32_bf16 v[32:35], v[72:75], v[92:95], v[32:35]
    ds_read_b128 v[124:127], v22
    ds_read_b128 v[128:131], v22 offset:2048
    ds_read_b64_tr_b16 v[104:105], v16 offset:8192
    v_mfma_f32_16x16x32_bf16 v[36:39], v[72:75], v[96:99], v[36:39]
    ds_read_b64_tr_b16 v[106:107], v16 offset:9216
    ds_read_b64_tr_b16 v[108:109], v17 offset:8192
    s_waitcnt lgkmcnt(12)
    v_mfma_f32_16x16x32_bf16 v[40:43], v[76:79], v[92:95], v[40:43]
    ds_read_b64_tr_b16 v[110:111], v17 offset:9216
    ds_read_b64_tr_b16 v[112:113], v18 offset:8192
    v_mfma_f32_16x16x32_bf16 v[44:47], v[76:79], v[96:99], v[44:47]
    s_waitcnt lgkmcnt(12)
    v_mfma_f32_16x16x32_bf16 v[48:51], v[80:83], v[92:95], v[48:51]
    ds_read_b64_tr_b16 v[114:115], v18 offset:9216
    ds_read_b64_tr_b16 v[116:117], v19 offset:8192
    v_mfma_f32_16x16x32_bf16 v[52:55], v[80:83], v[96:99], v[52:55]
    s_waitcnt lgkmcnt(12)
    v_mfma_f32_16x16x32_bf16 v[56:59], v[84:87], v[92:95], v[56:59]
    ds_read_b64_tr_b16 v[118:119], v19 offset:9216
    ds_read_b64_tr_b16 v[120:121], v20 offset:8192
    v_mfma_f32_16x16x32_bf16 v[60:63], v[84:87], v[96:99], v[60:63]
    s_waitcnt lgkmcnt(11)
    v_mfma_f32_16x16x32_bf16 v[64:67], v[88:91], v[100:103], v[64:67]
    ds_read_b64_tr_b16 v[122:123], v20 offset:9216
    ds_read_b128 v[132:135], v25
    s_waitcnt lgkmcnt(0)
    s_barrier
    v_add_u32 v16, 49152, v8
    v_add_u32 v17, 49152, v9
    v_add_u32 v18, 49152, v10
    v_add_u32 v19, 49152, v11
    v_add_u32 v20, 49152, v12
    v_add_u32 v21, 49152, v13
    v_add_u32 v22, 49152, v14
    v_add_u32 v23, 49152, v15
    v_add_u32 v25, 49152, v24
    v_mfma_f32_16x16x32_bf16 v[32:35], v[104:107], v[124:127], v[32:35]
    ds_read_b128 v[92:95], v21
    ds_read_b128 v[96:99], v21 offset:2048
    ds_read_b64_tr_b16 v[72:73], v16 offset:0
    v_mfma_f32_16x16x32_bf16 v[36:39], v[104:107], v[128:131], v[36:39]
    ds_read_b64_tr_b16 v[74:75], v16 offset:1024
    ds_read_b64_tr_b16 v[76:77], v17 offset:0
    ds_read_b64_tr_b16 v[78:79], v17 offset:1024
    v_mfma_f32_16x16x32_bf16 v[40:43], v[108:111], v[124:127], v[40:43]
    ds_read_b64_tr_b16 v[80:81], v18 offset:0
    ds_read_b64_tr_b16 v[82:83], v18 offset:1024
    ds_read_b64_tr_b16 v[84:85], v19 offset:0
    v_mfma_f32_16x16x32_bf16 v[44:47], v[108:111], v[128:131], v[44:47]
    ds_read_b64_tr_b16 v[86:87], v19 offset:1024
    ds_read_b64_tr_b16 v[88:89], v20 offset:0
    ds_read_b64_tr_b16 v[90:91], v20 offset:1024
    v_mfma_f32_16x16x32_bf16 v[48:51], v[112:115], v[124:127], v[48:51]
    ds_read_b128 v[100:103], v23
    v_mfma_f32_16x16x32_bf16 v[52:55], v[112:115], v[128:131], v[52:55]
    v_mfma_f32_16x16x32_bf16 v[56:59], v[116:119], v[124:127], v[56:59]
    v_mfma_f32_16x16x32_bf16 v[60:63], v[116:119], v[128:131], v[60:63]
    v_mfma_f32_16x16x32_bf16 v[64:67], v[120:123], v[132:135], v[64:67]
    s_waitcnt lgkmcnt(9)
    v_mfma_f32_16x16x32_bf16 v[32:35], v[72:75], v[92:95], v[32:35]
    ds_read_b128 v[124:127], v22
    ds_read_b128 v[128:131], v22 offset:2048
    ds_read_b64_tr_b16 v[104:105], v16 offset:8192
    v_mfma_f32_16x16x32_bf16 v[36:39], v[72:75], v[96:99], v[36:39]
    ds_read_b64_tr_b16 v[106:107], v16 offset:9216
    ds_read_b64_tr_b16 v[108:109], v17 offset:8192
    s_waitcnt lgkmcnt(12)
    v_mfma_f32_16x16x32_bf16 v[40:43], v[76:79], v[92:95], v[40:43]
    ds_read_b64_tr_b16 v[110:111], v17 offset:9216
    ds_read_b64_tr_b16 v[112:113], v18 offset:8192
    v_mfma_f32_16x16x32_bf16 v[44:47], v[76:79], v[96:99], v[44:47]
    s_waitcnt lgkmcnt(12)
    v_mfma_f32_16x16x32_bf16 v[48:51], v[80:83], v[92:95], v[48:51]
    ds_read_b64_tr_b16 v[114:115], v18 offset:9216
    ds_read_b64_tr_b16 v[116:117], v19 offset:8192
    v_mfma_f32_16x16x32_bf16 v[52:55], v[80:83], v[96:99], v[52:55]
    s_waitcnt lgkmcnt(12)
    v_mfma_f32_16x16x32_bf16 v[56:59], v[84:87], v[92:95], v[56:59]
    ds_read_b64_tr_b16 v[118:119], v19 offset:9216
    ds_read_b64_tr_b16 v[120:121], v20 offset:8192
    v_mfma_f32_16x16x32_bf16 v[60:63], v[84:87], v[96:99], v[60:63]
    s_waitcnt lgkmcnt(11)
    v_mfma_f32_16x16x32_bf16 v[64:67], v[88:91], v[100:103], v[64:67]
    ds_read_b64_tr_b16 v[122:123], v20 offset:9216
    ds_read_b128 v[132:135], v25
    s_waitcnt lgkmcnt(0)
    s_barrier
    v_add_u32 v16, 83968, v8
    v_add_u32 v17, 83968, v9
    v_add_u32 v18, 83968, v10
    v_add_u32 v19, 83968, v11
    v_add_u32 v20, 83968, v12
    v_add_u32 v21, 83968, v13
    v_add_u32 v22, 83968, v14
    v_add_u32 v23, 83968, v15
    v_add_u32 v25, 83968, v24
    v_mfma_f32_16x16x32_bf16 v[32:35], v[104:107], v[124:127], v[32:35]
    ds_read_b128 v[92:95], v21
    ds_read_b128 v[96:99], v21 offset:2048
    ds_read_b64_tr_b16 v[72:73], v16 offset:0
    v_mfma_f32_16x16x32_bf16 v[36:39], v[104:107], v[128:131], v[36:39]
    ds_read_b64_tr_b16 v[74:75], v16 offset:1024
    ds_read_b64_tr_b16 v[76:77], v17 offset:0
    ds_read_b64_tr_b16 v[78:79], v17 offset:1024
    v_mfma_f32_16x16x32_bf16 v[40:43], v[108:111], v[124:127], v[40:43]
    ds_read_b64_tr_b16 v[80:81], v18 offset:0
    ds_read_b64_tr_b16 v[82:83], v18 offset:1024
    ds_read_b64_tr_b16 v[84:85], v19 offset:0
    v_mfma_f32_16x16x32_bf16 v[44:47], v[108:111], v[128:131], v[44:47]
    ds_read_b64_tr_b16 v[86:87], v19 offset:1024
    ds_read_b64_tr_b16 v[88:89], v20 offset:0
    ds_read_b64_tr_b16 v[90:91], v20 offset:1024
    v_mfma_f32_16x16x32_bf16 v[48:51], v[112:115], v[124:127], v[48:51]
    ds_read_b128 v[100:103], v23
    v_mfma_f32_16x16x32_bf16 v[52:55], v[112:115], v[128:131], v[52:55]
    v_mfma_f32_16x16x32_bf16 v[56:59], v[116:119], v[124:127], v[56:59]
    v_mfma_f32_16x16x32_bf16 v[60:63], v[116:119], v[128:131], v[60:63]
    v_mfma_f32_16x16x32_bf16 v[64:67], v[120:123], v[132:135], v[64:67]
    s_waitcnt lgkmcnt(9)
    v_mfma_f32_16x16x32_bf16 v[32:35], v[72:75], v[92:95], v[32:35]
    ds_read_b128 v[124:127], v22
    ds_read_b128 v[128:131], v22 offset:2048
    ds_read_b64_tr_b16 v[104:105], v16 offset:8192
    v_mfma_f32_16x16x32_bf16 v[36:39], v[72:75], v[96:99], v[36:39]
    ds_read_b64_tr_b16 v[106:107], v16 offset:9216
    ds_read_b64_tr_b16 v[108:109], v17 offset:8192
    s_waitcnt lgkmcnt(12)
    v_mfma_f32_16x16x32_bf16 v[40:43], v[76:79], v[92:95], v[40:43]
    ds_read_b64_tr_b16 v[110:111], v17 offset:9216
    ds_read_b64_tr_b16 v[112:113], v18 offset:8192
    v_mfma_f32_16x16x32_bf16 v[44:47], v[76:79], v[96:99], v[44:47]
    s_waitcnt lgkmcnt(12)
    v_mfma_f32_16x16x32_bf16 v[48:51], v[80:83], v[92:95], v[48:51]
    ds_read_b64_tr_b16 v[114:115], v18 offset:9216
    ds_read_b64_tr_b16 v[116:117], v19 offset:8192
    v_mfma_f32_16x16x32_bf16 v[52:55], v[80:83], v[96:99], v[52:55]
    s_waitcnt lgkmcnt(12)
    v_mfma_f32_16x16x32_bf16 v[56:59], v[84:87], v[92:95], v[56:59]
    ds_read_b64_tr_b16 v[118:119], v19 offset:9216
    ds_read_b64_tr_b16 v[120:121], v20 offset:8192
    v_mfma_f32_16x16x32_bf16 v[60:63], v[84:87], v[96:99], v[60:63]
    s_waitcnt lgkmcnt(11)
    v_mfma_f32_16x16x32_bf16 v[64:67], v[88:91], v[100:103], v[64:67]
    ds_read_b64_tr_b16 v[122:123], v20 offset:9216
    ds_read_b128 v[132:135], v25
    s_waitcnt lgkmcnt(0)
    s_barrier
    v_add_u32 v16, 118784, v8
    v_add_u32 v17, 118784, v9
    v_add_u32 v18, 118784, v10
    v_add_u32 v19, 118784, v11
    v_add_u32 v20, 118784, v12
    v_add_u32 v21, 118784, v13
    v_add_u32 v22, 118784, v14
    v_add_u32 v23, 118784, v15
    v_add_u32 v25, 118784, v24
    v_mfma_f32_16x16x32_bf16 v[32:35], v[104:107], v[124:127], v[32:35]
    ds_read_b128 v[92:95], v21
    ds_read_b128 v[96:99], v21 offset:2048
    ds_read_b64_tr_b16 v[72:73], v16 offset:0
    v_mfma_f32_16x16x32_bf16 v[36:39], v[104:107], v[128:131], v[36:39]
    ds_read_b64_tr_b16 v[74:75], v16 offset:1024
    ds_read_b64_tr_b16 v[76:77], v17 offset:0
    ds_read_b64_tr_b16 v[78:79], v17 offset:1024
    v_mfma_f32_16x16x32_bf16 v[40:43], v[108:111], v[124:127], v[40:43]
    ds_read_b64_tr_b16 v[80:81], v18 offset:0
    ds_read_b64_tr_b16 v[82:83], v18 offset:1024
    ds_read_b64_tr_b16 v[84:85], v19 offset:0
    v_mfma_f32_16x16x32_bf16 v[44:47], v[108:111], v[128:131], v[44:47]
    ds_read_b64_tr_b16 v[86:87], v19 offset:1024
    ds_read_b64_tr_b16 v[88:89], v20 offset:0
    ds_read_b64_tr_b16 v[90:91], v20 offset:1024
    v_mfma_f32_16x16x32_bf16 v[48:51], v[112:115], v[124:127], v[48:51]
    ds_read_b128 v[100:103], v23
    v_mfma_f32_16x16x32_bf16 v[52:55], v[112:115], v[128:131], v[52:55]
    v_mfma_f32_16x16x32_bf16 v[56:59], v[116:119], v[124:127], v[56:59]
    v_mfma_f32_16x16x32_bf16 v[60:63], v[116:119], v[128:131], v[60:63]
    v_mfma_f32_16x16x32_bf16 v[64:67], v[120:123], v[132:135], v[64:67]
    s_waitcnt lgkmcnt(9)
    v_mfma_f32_16x16x32_bf16 v[32:35], v[72:75], v[92:95], v[32:35]
    ds_read_b128 v[124:127], v22
    ds_read_b128 v[128:131], v22 offset:2048
    ds_read_b64_tr_b16 v[104:105], v16 offset:8192
    v_mfma_f32_16x16x32_bf16 v[36:39], v[72:75], v[96:99], v[36:39]
    ds_read_b64_tr_b16 v[106:107], v16 offset:9216
    ds_read_b64_tr_b16 v[108:109], v17 offset:8192
    s_waitcnt lgkmcnt(12)
    v_mfma_f32_16x16x32_bf16 v[40:43], v[76:79], v[92:95], v[40:43]
    ds_read_b64_tr_b16 v[110:111], v17 offset:9216
    ds_read_b64_tr_b16 v[112:113], v18 offset:8192
    v_mfma_f32_16x16x32_bf16 v[44:47], v[76:79], v[96:99], v[44:47]
    s_waitcnt lgkmcnt(12)
    v_mfma_f32_16x16x32_bf16 v[48:51], v[80:83], v[92:95], v[48:51]
    ds_read_b64_tr_b16 v[114:115], v18 offset:9216
    ds_read_b64_tr_b16 v[116:117], v19 offset:8192
    v_mfma_f32_16x16x32_bf16 v[52:55], v[80:83], v[96:99], v[52:55]
    s_waitcnt lgkmcnt(12)
    v_mfma_f32_16x16x32_bf16 v[56:59], v[84:87], v[92:95], v[56:59]
    ds_read_b64_tr_b16 v[118:119], v19 offset:9216
    ds_read_b64_tr_b16 v[120:121], v20 offset:8192
    v_mfma_f32_16x16x32_bf16 v[60:63], v[84:87], v[96:99], v[60:63]
    s_waitcnt lgkmcnt(11)
    v_mfma_f32_16x16x32_bf16 v[64:67], v[88:91], v[100:103], v[64:67]
    ds_read_b64_tr_b16 v[122:123], v20 offset:9216
    ds_read_b128 v[132:135], v25
    s_waitcnt lgkmcnt(0)
    s_barrier
    v_add_u32 v16, 49152, v8
    v_add_u32 v17, 49152, v9
    v_add_u32 v18, 49152, v10
    v_add_u32 v19, 49152, v11
    v_add_u32 v20, 49152, v12
    v_add_u32 v21, 49152, v13
    v_add_u32 v22, 49152, v14
    v_add_u32 v23, 49152, v15
    v_add_u32 v25, 49152, v24
    v_mfma_f32_16x16x32_bf16 v[32:35], v[104:107], v[124:127], v[32:35]
    ds_read_b128 v[92:95], v21
    ds_read_b128 v[96:99], v21 offset:2048
    ds_read_b64_tr_b16 v[72:73], v16 offset:0
    v_mfma_f32_16x16x32_bf16 v[36:39], v[104:107], v[128:131], v[36:39]
    ds_read_b64_tr_b16 v[74:75], v16 offset:1024
    ds_read_b64_tr_b16 v[76:77], v17 offset:0
    ds_read_b64_tr_b16 v[78:79], v17 offset:1024
    v_mfma_f32_16x16x32_bf16 v[40:43], v[108:111], v[124:127], v[40:43]
    ds_read_b64_tr_b16 v[80:81], v18 offset:0
    ds_read_b64_tr_b16 v[82:83], v18 offset:1024
    ds_read_b64_tr_b16 v[84:85], v19 offset:0
    v_mfma_f32_16x16x32_bf16 v[44:47], v[108:111], v[128:131], v[44:47]
    ds_read_b64_tr_b16 v[86:87], v19 offset:1024
    ds_read_b64_tr_b16 v[88:89], v20 offset:0
    ds_read_b64_tr_b16 v[90:91], v20 offset:1024
    v_mfma_f32_16x16x32_bf16 v[48:51], v[112:115], v[124:127], v[48:51]
    ds_read_b128 v[100:103], v23
    v_mfma_f32_16x16x32_bf16 v[52:55], v[112:115], v[128:131], v[52:55]
    v_mfma_f32_16x16x32_bf16 v[56:59], v[116:119], v[124:127], v[56:59]
    v_mfma_f32_16x16x32_bf16 v[60:63], v[116:119], v[128:131], v[60:63]
    v_mfma_f32_16x16x32_bf16 v[64:67], v[120:123], v[132:135], v[64:67]
    s_waitcnt lgkmcnt(9)
    v_mfma_f32_16x16x32_bf16 v[32:35], v[72:75], v[92:95], v[32:35]
    ds_read_b128 v[124:127], v22
    ds_read_b128 v[128:131], v22 offset:2048
    ds_read_b64_tr_b16 v[104:105], v16 offset:8192
    v_mfma_f32_16x16x32_bf16 v[36:39], v[72:75], v[96:99], v[36:39]
    ds_read_b64_tr_b16 v[106:107], v16 offset:9216
    ds_read_b64_tr_b16 v[108:109], v17 offset:8192
    s_waitcnt lgkmcnt(12)
    v_mfma_f32_16x16x32_bf16 v[40:43], v[76:79], v[92:95], v[40:43]
    ds_read_b64_tr_b16 v[110:111], v17 offset:9216
    ds_read_b64_tr_b16 v[112:113], v18 offset:8192
    v_mfma_f32_16x16x32_bf16 v[44:47], v[76:79], v[96:99], v[44:47]
    s_waitcnt lgkmcnt(12)
    v_mfma_f32_16x16x32_bf16 v[48:51], v[80:83], v[92:95], v[48:51]
    ds_read_b64_tr_b16 v[114:115], v18 offset:9216
    ds_read_b64_tr_b16 v[116:117], v19 offset:8192
    v_mfma_f32_16x16x32_bf16 v[52:55], v[80:83], v[96:99], v[52:55]
    s_waitcnt lgkmcnt(12)
    v_mfma_f32_16x16x32_bf16 v[56:59], v[84:87], v[92:95], v[56:59]
    ds_read_b64_tr_b16 v[118:119], v19 offset:9216
    ds_read_b64_tr_b16 v[120:121], v20 offset:8192
    v_mfma_f32_16x16x32_bf16 v[60:63], v[84:87], v[96:99], v[60:63]
    s_waitcnt lgkmcnt(11)
    v_mfma_f32_16x16x32_bf16 v[64:67], v[88:91], v[100:103], v[64:67]
    ds_read_b64_tr_b16 v[122:123], v20 offset:9216
    ds_read_b128 v[132:135], v25
    s_waitcnt lgkmcnt(0)
    s_barrier
    v_add_u32 v16, 83968, v8
    v_add_u32 v17, 83968, v9
    v_add_u32 v18, 83968, v10
    v_add_u32 v19, 83968, v11
    v_add_u32 v20, 83968, v12
    v_add_u32 v21, 83968, v13
    v_add_u32 v22, 83968, v14
    v_add_u32 v23, 83968, v15
    v_add_u32 v25, 83968, v24
    v_mfma_f32_16x16x32_bf16 v[32:35], v[104:107], v[124:127], v[32:35]
    ds_read_b128 v[92:95], v21
    ds_read_b128 v[96:99], v21 offset:2048
    ds_read_b64_tr_b16 v[72:73], v16 offset:0
    v_mfma_f32_16x16x32_bf16 v[36:39], v[104:107], v[128:131], v[36:39]
    ds_read_b64_tr_b16 v[74:75], v16 offset:1024
    ds_read_b64_tr_b16 v[76:77], v17 offset:0
    ds_read_b64_tr_b16 v[78:79], v17 offset:1024
    v_mfma_f32_16x16x32_bf16 v[40:43], v[108:111], v[124:127], v[40:43]
    ds_read_b64_tr_b16 v[80:81], v18 offset:0
    ds_read_b64_tr_b16 v[82:83], v18 offset:1024
    ds_read_b64_tr_b16 v[84:85], v19 offset:0
    v_mfma_f32_16x16x32_bf16 v[44:47], v[108:111], v[128:131], v[44:47]
    ds_read_b64_tr_b16 v[86:87], v19 offset:1024
    ds_read_b64_tr_b16 v[88:89], v20 offset:0
    ds_read_b64_tr_b16 v[90:91], v20 offset:1024
    v_mfma_f32_16x16x32_bf16 v[48:51], v[112:115], v[124:127], v[48:51]
    ds_read_b128 v[100:103], v23
    s_add_u32 m0, s46, 49152
    s_mov_b32 s57, 49152
    buffer_load_dwordx4 v2, s[24:27], s57 offen nt lds
    v_mfma_f32_16x16x32_bf16 v[52:55], v[112:115], v[128:131], v[52:55]
    s_add_u32 m0, s46, 50176
    s_mov_b32 s57, 49152
    buffer_load_dwordx4 v3, s[24:27], s57 offen nt lds
    v_mfma_f32_16x16x32_bf16 v[56:59], v[116:119], v[124:127], v[56:59]
    s_add_u32 m0, s46, 51200
    s_mov_b32 s57, 49152
    buffer_load_dwordx4 v4, s[24:27], s57 offen nt lds
    v_mfma_f32_16x16x32_bf16 v[60:63], v[116:119], v[128:131], v[60:63]
    s_add_u32 m0, s46, 52224
    s_mov_b32 s57, 49152
    buffer_load_dwordx4 v5, s[24:27], s57 offen nt lds
    v_mfma_f32_16x16x32_bf16 v[64:67], v[120:123], v[132:135], v[64:67]
    s_add_u32 m0, s46, 65536
    s_mov_b32 s57, 0
    buffer_load_dwordx4 v6, s[28:31], s57 offen nt lds
    s_waitcnt lgkmcnt(9)
    v_mfma_f32_16x16x32_bf16 v[32:35], v[72:75], v[92:95], v[32:35]
    ds_read_b128 v[124:127], v22
    ds_read_b128 v[128:131], v22 offset:2048
    ds_read_b64_tr_b16 v[104:105], v16 offset:8192
    v_mfma_f32_16x16x32_bf16 v[36:39], v[72:75], v[96:99], v[36:39]
    ds_read_b64_tr_b16 v[106:107], v16 offset:9216
    ds_read_b64_tr_b16 v[108:109], v17 offset:8192
    s_waitcnt lgkmcnt(12)
    v_mfma_f32_16x16x32_bf16 v[40:43], v[76:79], v[92:95], v[40:43]
    ds_read_b64_tr_b16 v[110:111], v17 offset:9216
    ds_read_b64_tr_b16 v[112:113], v18 offset:8192
    v_mfma_f32_16x16x32_bf16 v[44:47], v[76:79], v[96:99], v[44:47]
    s_waitcnt lgkmcnt(12)
    v_mfma_f32_16x16x32_bf16 v[48:51], v[80:83], v[92:95], v[48:51]
    ds_read_b64_tr_b16 v[114:115], v18 offset:9216
    ds_read_b64_tr_b16 v[116:117], v19 offset:8192
    v_mfma_f32_16x16x32_bf16 v[52:55], v[80:83], v[96:99], v[52:55]
    s_waitcnt lgkmcnt(12)
    v_mfma_f32_16x16x32_bf16 v[56:59], v[84:87], v[92:95], v[56:59]
    ds_read_b64_tr_b16 v[118:119], v19 offset:9216
    ds_read_b64_tr_b16 v[120:121], v20 offset:8192
    v_mfma_f32_16x16x32_bf16 v[60:63], v[84:87], v[96:99], v[60:63]
    s_waitcnt lgkmcnt(11)
    v_mfma_f32_16x16x32_bf16 v[64:67], v[88:91], v[100:103], v[64:67]
    ds_read_b64_tr_b16 v[122:123], v20 offset:9216
    ds_read_b128 v[132:135], v25
    s_add_u32 m0, s46, 65536
    s_mov_b32 s57, 0
    buffer_load_dwordx4 v6, s[28:31], s57 offen offset:2048 nt lds
    s_waitcnt lgkmcnt(0)
    s_add_u32 m0, s46, 66560
    s_mov_b32 s57, 0
    buffer_load_dwordx4 v7, s[28:31], s57 offen nt lds
    s_add_u32 m0, s46, 66560
    s_mov_b32 s57, 0
    buffer_load_dwordx4 v7, s[28:31], s57 offen offset:2048 nt lds
    s_barrier
    v_add_u32 v16, 118784, v8
    v_add_u32 v17, 118784, v9
    v_add_u32 v18, 118784, v10
    v_add_u32 v19, 118784, v11
    v_add_u32 v20, 118784, v12
    v_add_u32 v21, 118784, v13
    v_add_u32 v22, 118784, v14
    v_add_u32 v23, 118784, v15
    v_add_u32 v25, 118784, v24
    v_mfma_f32_16x16x32_bf16 v[32:35], v[104:107], v[124:127], v[32:35]
    ds_read_b128 v[92:95], v21
    ds_read_b128 v[96:99], v21 offset:2048
    ds_read_b64_tr_b16 v[72:73], v16 offset:0
    v_mfma_f32_16x16x32_bf16 v[36:39], v[104:107], v[128:131], v[36:39]
    ds_read_b64_tr_b16 v[74:75], v16 offset:1024
    ds_read_b64_tr_b16 v[76:77], v17 offset:0
    ds_read_b64_tr_b16 v[78:79], v17 offset:1024
    v_mfma_f32_16x16x32_bf16 v[40:43], v[108:111], v[124:127], v[40:43]
    ds_read_b64_tr_b16 v[80:81], v18 offset:0
    ds_read_b64_tr_b16 v[82:83], v18 offset:1024
    ds_read_b64_tr_b16 v[84:85], v19 offset:0
    v_mfma_f32_16x16x32_bf16 v[44:47], v[108:111], v[128:131], v[44:47]
    ds_read_b64_tr_b16 v[86:87], v19 offset:1024
    ds_read_b64_tr_b16 v[88:89], v20 offset:0
    ds_read_b64_tr_b16 v[90:91], v20 offset:1024
    v_mfma_f32_16x16x32_bf16 v[48:51], v[112:115], v[124:127], v[48:51]
    ds_read_b128 v[100:103], v23
    v_mfma_f32_16x16x32_bf16 v[52:55], v[112:115], v[128:131], v[52:55]
    v_mfma_f32_16x16x32_bf16 v[56:59], v[116:119], v[124:127], v[56:59]
    v_mfma_f32_16x16x32_bf16 v[60:63], v[116:119], v[128:131], v[60:63]
    v_mfma_f32_16x16x32_bf16 v[64:67], v[120:123], v[132:135], v[64:67]
    s_waitcnt lgkmcnt(9)
    v_mfma_f32_16x16x32_bf16 v[32:35], v[72:75], v[92:95], v[32:35]
    ds_read_b128 v[124:127], v22
    ds_read_b128 v[128:131], v22 offset:2048
    ds_read_b64_tr_b16 v[104:105], v16 offset:8192
    v_mfma_f32_16x16x32_bf16 v[36:39], v[72:75], v[96:99], v[36:39]
    ds_read_b64_tr_b16 v[106:107], v16 offset:9216
    ds_read_b64_tr_b16 v[108:109], v17 offset:8192
    s_waitcnt lgkmcnt(12)
    v_mfma_f32_16x16x32_bf16 v[40:43], v[76:79], v[92:95], v[40:43]
    ds_read_b64_tr_b16 v[110:111], v17 offset:9216
    ds_read_b64_tr_b16 v[112:113], v18 offset:8192
    v_mfma_f32_16x16x32_bf16 v[44:47], v[76:79], v[96:99], v[44:47]
    s_waitcnt lgkmcnt(12)
    v_mfma_f32_16x16x32_bf16 v[48:51], v[80:83], v[92:95], v[48:51]
    ds_read_b64_tr_b16 v[114:115], v18 offset:9216
    ds_read_b64_tr_b16 v[116:117], v19 offset:8192
    v_mfma_f32_16x16x32_bf16 v[52:55], v[80:83], v[96:99], v[52:55]
    s_waitcnt lgkmcnt(12)
    v_mfma_f32_16x16x32_bf16 v[56:59], v[84:87], v[92:95], v[56:59]
    ds_read_b64_tr_b16 v[118:119], v19 offset:9216
    ds_read_b64_tr_b16 v[120:121], v20 offset:8192
    v_mfma_f32_16x16x32_bf16 v[60:63], v[84:87], v[96:99], v[60:63]
    s_waitcnt lgkmcnt(11)
    v_mfma_f32_16x16x32_bf16 v[64:67], v[88:91], v[100:103], v[64:67]
    ds_read_b64_tr_b16 v[122:123], v20 offset:9216
    ds_read_b128 v[132:135], v25
    s_waitcnt lgkmcnt(9)
    v_mfma_f32_16x16x32_bf16 v[32:35], v[104:107], v[124:127], v[32:35]
    v_mfma_f32_16x16x32_bf16 v[36:39], v[104:107], v[128:131], v[36:39]
    s_waitcnt lgkmcnt(7)
    v_mfma_f32_16x16x32_bf16 v[40:43], v[108:111], v[124:127], v[40:43]
    v_mfma_f32_16x16x32_bf16 v[44:47], v[108:111], v[128:131], v[44:47]
    s_waitcnt lgkmcnt(5)
    v_mfma_f32_16x16x32_bf16 v[48:51], v[112:115], v[124:127], v[48:51]
    v_mfma_f32_16x16x32_bf16 v[52:55], v[112:115], v[128:131], v[52:55]
    s_waitcnt lgkmcnt(3)
    v_mfma_f32_16x16x32_bf16 v[56:59], v[116:119], v[124:127], v[56:59]
    v_mfma_f32_16x16x32_bf16 v[60:63], v[116:119], v[128:131], v[60:63]
    s_waitcnt lgkmcnt(0)
    v_mfma_f32_16x16x32_bf16 v[64:67], v[120:123], v[132:135], v[64:67]
    s_waitcnt lgkmcnt(0)
    s_lshl_b32 s47, s45, 5
    v_add_u32 v1, s47, v27
    v_mul_u32_u24 v1, 272, v1
    v_lshl_add_u32 v12, v28, 4, v1
    v_add_u32 v12, 83968, v12
    v_lshl_add_u32 v1, v28, 3, v1
    v_add_u32 v1, 84096, v1
    v_mul_u32_u24 v8, 272, v27
    v_lshl_add_u32 v13, v28, 4, v8
    v_add_u32 v13, 153600, v13
    v_lshl_add_u32 v8, v28, 3, v8
    s_lshl_b32 s47, s44, 5
    s_add_u32 s47, s47, 153600
    v_add_u32 v8, s47, v8
    v_cvt_pk_bf16_f32 v72, v32, v33
    v_cvt_pk_bf16_f32 v73, v34, v35
    ds_write_b64 v1, v[72:73] offset:0
    v_cvt_pk_bf16_f32 v74, v36, v37
    v_cvt_pk_bf16_f32 v75, v38, v39
    ds_write_b64 v1, v[74:75] offset:4352
    v_cvt_pk_bf16_f32 v76, v40, v41
    v_cvt_pk_bf16_f32 v77, v42, v43
    ds_write_b64 v1, v[76:77] offset:32
    v_cvt_pk_bf16_f32 v78, v44, v45
    v_cvt_pk_bf16_f32 v79, v46, v47
    ds_write_b64 v1, v[78:79] offset:4384
    v_cvt_pk_bf16_f32 v80, v48, v49
    v_cvt_pk_bf16_f32 v81, v50, v51
    ds_write_b64 v1, v[80:81] offset:64
    v_cvt_pk_bf16_f32 v82, v52, v53
    v_cvt_pk_bf16_f32 v83, v54, v55
    ds_write_b64 v1, v[82:83] offset:4416
    v_cvt_pk_bf16_f32 v84, v56, v57
    v_cvt_pk_bf16_f32 v85, v58, v59
    ds_write_b64 v1, v[84:85] offset:96
    v_cvt_pk_bf16_f32 v86, v60, v61
    v_cvt_pk_bf16_f32 v87, v62, v63
    ds_write_b64 v1, v[86:87] offset:4448
    v_cvt_pk_bf16_f32 v88, v64, v65
    v_cvt_pk_bf16_f32 v89, v66, v67
    ds_write_b64 v8, v[88:89]
    s_waitcnt lgkmcnt(0)
    s_barrier
    ds_read_b128 v[32:35], v12 offset:0
    ds_read_b128 v[36:39], v12 offset:64
    ds_read_b128 v[40:43], v12 offset:128
    ds_read_b128 v[44:47], v12 offset:192
    ds_read_b128 v[48:51], v12 offset:4352
    ds_read_b128 v[52:55], v12 offset:4416
    ds_read_b128 v[56:59], v12 offset:4480
    ds_read_b128 v[60:63], v12 offset:4544
    ds_read_b128 v[64:67], v13 offset:0
    ds_read_b128 v[68:71], v13 offset:64
    ds_read_b128 v[72:75], v13 offset:128
    ds_read_b128 v[76:79], v13 offset:192
    v_lshlrev_b32 v1, 8, v27
    v_add_u32 v8, 0, v28
    v_xor_b32 v8, v8, v27
    v_lshl_add_u32 v8, v8, 4, v1
    v_add_u32 v9, 4, v28
    v_xor_b32 v9, v9, v27
    v_lshl_add_u32 v9, v9, 4, v1
    v_add_u32 v10, 8, v28
    v_xor_b32 v10, v10, v27
    v_lshl_add_u32 v10, v10, 4, v1
    v_add_u32 v11, 12, v28
    v_xor_b32 v11, v11, v27
    v_lshl_add_u32 v11, v11, 4, v1
    s_waitcnt lgkmcnt(0)
    s_waitcnt vmcnt(16)
    s_barrier
    s_add_u32 m0, s46, 118784
    s_mov_b32 s57, 65536
    buffer_load_dwordx4 v2, s[24:27], s57 offen nt lds
    s_add_u32 m0, s46, 119808
    s_mov_b32 s57, 65536
    buffer_load_dwordx4 v3, s[24:27], s57 offen nt lds
    s_add_u32 m0, s46, 120832
    s_mov_b32 s57, 65536
    buffer_load_dwordx4 v4, s[24:27], s57 offen nt lds
    s_add_u32 m0, s46, 121856
    s_mov_b32 s57, 65536
    buffer_load_dwordx4 v5, s[24:27], s57 offen nt lds
    s_add_u32 m0, s46, 135168
    s_mov_b32 s57, 16384
    buffer_load_dwordx4 v6, s[28:31], s57 offen nt lds
    s_add_u32 m0, s46, 135168
    s_mov_b32 s57, 16384
    buffer_load_dwordx4 v6, s[28:31], s57 offen offset:2048 nt lds
    s_add_u32 m0, s46, 136192
    s_mov_b32 s57, 16384
    buffer_load_dwordx4 v7, s[28:31], s57 offen nt lds
    s_add_u32 m0, s46, 136192
    s_mov_b32 s57, 16384
    buffer_load_dwordx4 v7, s[28:31], s57 offen offset:2048 nt lds
    s_waitcnt vmcnt(20)
    s_barrier
    s_add_u32 m0, s46, 83968
    s_mov_b32 s57, 81920
    buffer_load_dwordx4 v2, s[24:27], s57 offen nt lds
    s_add_u32 m0, s46, 84992
    s_mov_b32 s57, 81920
    buffer_load_dwordx4 v3, s[24:27], s57 offen nt lds
    s_add_u32 m0, s46, 86016
    s_mov_b32 s57, 81920
    buffer_load_dwordx4 v4, s[24:27], s57 offen nt lds
    s_add_u32 m0, s46, 87040
    s_mov_b32 s57, 81920
    buffer_load_dwordx4 v5, s[24:27], s57 offen nt lds
    s_add_u32 m0, s46, 100352
    s_mov_b32 s57, 32768
    buffer_load_dwordx4 v6, s[28:31], s57 offen nt lds
    s_add_u32 m0, s46, 100352
    s_mov_b32 s57, 32768
    buffer_load_dwordx4 v6, s[28:31], s57 offen offset:2048 nt lds
    s_add_u32 m0, s46, 101376
    s_mov_b32 s57, 32768
    buffer_load_dwordx4 v7, s[28:31], s57 offen nt lds
    s_add_u32 m0, s46, 101376
    s_mov_b32 s57, 32768
    buffer_load_dwordx4 v7, s[28:31], s57 offen offset:2048 nt lds
    s_waitcnt vmcnt(24)
    s_barrier
    s_add_u32 m0, s46, 0
    s_mov_b32 s57, 98304
    buffer_load_dwordx4 v2, s[24:27], s57 offen nt lds
    s_add_u32 m0, s46, 1024
    s_mov_b32 s57, 98304
    buffer_load_dwordx4 v3, s[24:27], s57 offen nt lds
    s_add_u32 m0, s46, 2048
    s_mov_b32 s57, 98304
    buffer_load_dwordx4 v4, s[24:27], s57 offen nt lds
    s_add_u32 m0, s46, 3072
    s_mov_b32 s57, 98304
    buffer_load_dwordx4 v5, s[24:27], s57 offen nt lds
    s_add_u32 m0, s46, 16384
    s_mov_b32 s57, 49152
    buffer_load_dwordx4 v6, s[28:31], s57 offen nt lds
    s_add_u32 m0, s46, 16384
    s_mov_b32 s57, 49152
    buffer_load_dwordx4 v6, s[28:31], s57 offen offset:2048 nt lds
    s_add_u32 m0, s46, 17408
    s_mov_b32 s57, 49152
    buffer_load_dwordx4 v7, s[28:31], s57 offen nt lds
    s_add_u32 m0, s46, 17408
    s_mov_b32 s57, 49152
    buffer_load_dwordx4 v7, s[28:31], s57 offen offset:2048 nt lds
    s_waitcnt vmcnt(28)
    s_barrier
    s_add_u32 m0, s46, 32768
    s_mov_b32 s57, 114688
    buffer_load_dwordx4 v2, s[24:27], s57 offen nt lds
    s_add_u32 m0, s46, 33792
    s_mov_b32 s57, 114688
    buffer_load_dwordx4 v3, s[24:27], s57 offen nt lds
    s_add_u32 m0, s46, 34816
    s_mov_b32 s57, 114688
    buffer_load_dwordx4 v4, s[24:27], s57 offen nt lds
    s_add_u32 m0, s46, 35840
    s_mov_b32 s57, 114688
    buffer_load_dwordx4 v5, s[24:27], s57 offen nt lds
    s_barrier
    s_add_u32 m0, s46, 49152
    s_mov_b32 s57, 65536
    buffer_load_dwordx4 v6, s[28:31], s57 offen nt lds
    s_add_u32 m0, s46, 49152
    s_mov_b32 s57, 65536
    buffer_load_dwordx4 v6, s[28:31], s57 offen offset:2048 nt lds
    s_add_u32 m0, s46, 50176
    s_mov_b32 s57, 65536
    buffer_load_dwordx4 v7, s[28:31], s57 offen nt lds
    s_add_u32 m0, s46, 50176
    s_mov_b32 s57, 65536
    buffer_load_dwordx4 v7, s[28:31], s57 offen offset:2048 nt lds
    s_barrier
    s_waitcnt vmcnt(28)
    s_barrier
    v_add_u32 v16, 118784, v8
    v_add_u32 v17, 118784, v9
    v_add_u32 v18, 118784, v10
    v_add_u32 v19, 118784, v11
    ds_read_b128 v[224:227], v16 offset:0
    ds_read_b128 v[228:231], v17 offset:0
    ds_read_b128 v[232:235], v18 offset:0
    ds_read_b128 v[236:239], v19 offset:0
    s_waitcnt lgkmcnt(3)
    v_mfma_f32_16x16x32_bf16 v[80:83], v[224:227], v[32:35], 0
    ds_read_b128 v[240:243], v16 offset:4096
    v_mfma_f32_16x16x32_bf16 v[84:87], v[224:227], v[48:51], 0
    ds_read_b128 v[244:247], v17 offset:4096
    s_waitcnt lgkmcnt(4)
    v_mfma_f32_16x16x32_bf16 v[80:83], v[228:231], v[36:39], v[80:83]
    ds_read_b128 v[248:251], v18 offset:4096
    v_mfma_f32_16x16x32_bf16 v[84:87], v[228:231], v[52:55], v[84:87]
    ds_read_b128 v[252:255], v19 offset:4096
    s_waitcnt lgkmcnt(5)
    v_mfma_f32_16x16x32_bf16 v[80:83], v[232:235], v[40:43], v[80:83]
    v_mfma_f32_16x16x32_bf16 v[84:87], v[232:235], v[56:59], v[84:87]
    s_waitcnt lgkmcnt(4)
    v_mfma_f32_16x16x32_bf16 v[80:83], v[236:239], v[44:47], v[80:83]
    v_mfma_f32_16x16x32_bf16 v[84:87], v[236:239], v[60:63], v[84:87]
    s_cmp_eq_u32 s45, 0
    s_cbranch_scc0 .L33
    v_mfma_f32_16x16x32_bf16 v[208:211], v[224:227], v[64:67], 0
    v_mfma_f32_16x16x32_bf16 v[208:211], v[228:231], v[68:71], v[208:211]
    v_mfma_f32_16x16x32_bf16 v[208:211], v[232:235], v[72:75], v[208:211]
    v_mfma_f32_16x16x32_bf16 v[208:211], v[236:239], v[76:79], v[208:211]
.L33:
    s_waitcnt lgkmcnt(3)
    v_mfma_f32_16x16x32_bf16 v[88:91], v[240:243], v[32:35], 0
    ds_read_b128 v[224:227], v16 offset:8192
    v_mfma_f32_16x16x32_bf16 v[92:95], v[240:243], v[48:51], 0
    ds_read_b128 v[228:231], v17 offset:8192
    s_waitcnt lgkmcnt(4)
    v_mfma_f32_16x16x32_bf16 v[88:91], v[244:247], v[36:39], v[88:91]
    ds_read_b128 v[232:235], v18 offset:8192
    v_mfma_f32_16x16x32_bf16 v[92:95], v[244:247], v[52:55], v[92:95]
    ds_read_b128 v[236:239], v19 offset:8192
    s_waitcnt lgkmcnt(5)
    v_mfma_f32_16x16x32_bf16 v[88:91], v[248:251], v[40:43], v[88:91]
    v_mfma_f32_16x16x32_bf16 v[92:95], v[248:251], v[56:59], v[92:95]
    s_waitcnt lgkmcnt(4)
    v_mfma_f32_16x16x32_bf16 v[88:91], v[252:255], v[44:47], v[88:91]
    v_mfma_f32_16x16x32_bf16 v[92:95], v[252:255], v[60:63], v[92:95]
    s_cmp_eq_u32 s45, 0
    s_cbranch_scc0 .L34
    v_mfma_f32_16x16x32_bf16 v[212:215], v[240:243], v[64:67], 0
    v_mfma_f32_16x16x32_bf16 v[212:215], v[244:247], v[68:71], v[212:215]
    v_mfma_f32_16x16x32_bf16 v[212:215], v[248:251], v[72:75], v[212:215]
    v_mfma_f32_16x16x32_bf16 v[212:215], v[252:255], v[76:79], v[212:215]
.L34:
    s_waitcnt lgkmcnt(3)
    v_mfma_f32_16x16x32_bf16 v[96:99], v[224:227], v[32:35], 0
    ds_read_b128 v[240:243], v16 offset:12288
    v_max3_f32 v20, v80, v81, v82
    v_mfma_f32_16x16x32_bf16 v[100:103], v[224:227], v[48:51], 0
    ds_read_b128 v[244:247], v17 offset:12288
    v_max_f32 v20, v20, v83
    s_waitcnt lgkmcnt(4)
    v_mfma_f32_16x16x32_bf16 v[96:99], v[228:231], v[36:39], v[96:99]
    ds_read_b128 v[248:251], v18 offset:12288
    v_max3_f32 v21, v84, v85, v86
    v_mfma_f32_16x16x32_bf16 v[100:103], v[228:231], v[52:55], v[100:103]
    ds_read_b128 v[252:255], v19 offset:12288
    v_max_f32 v21, v21, v87
    s_waitcnt lgkmcnt(5)
    v_mfma_f32_16x16x32_bf16 v[96:99], v[232:235], v[40:43], v[96:99]
    v_mfma_f32_16x16x32_bf16 v[100:103], v[232:235], v[56:59], v[100:103]
    s_waitcnt lgkmcnt(4)
    v_mfma_f32_16x16x32_bf16 v[96:99], v[236:239], v[44:47], v[96:99]
    v_mfma_f32_16x16x32_bf16 v[100:103], v[236:239], v[60:63], v[100:103]
    s_cmp_eq_u32 s45, 0
    s_cbranch_scc0 .L35
    v_mfma_f32_16x16x32_bf16 v[216:219], v[224:227], v[64:67], 0
    v_mfma_f32_16x16x32_bf16 v[216:219], v[228:231], v[68:71], v[216:219]
    v_mfma_f32_16x16x32_bf16 v[216:219], v[232:235], v[72:75], v[216:219]
    v_mfma_f32_16x16x32_bf16 v[216:219], v[236:239], v[76:79], v[216:219]
.L35:
    s_waitcnt lgkmcnt(0)
    s_waitcnt vmcnt(20)
    s_barrier
    v_add_u32 v16, 83968, v8
    v_add_u32 v17, 83968, v9
    v_add_u32 v18, 83968, v10
    v_add_u32 v19, 83968, v11
    v_mfma_f32_16x16x32_bf16 v[104:107], v[240:243], v[32:35], 0
    ds_read_b128 v[224:227], v16 offset:0
    v_max3_f32 v20, v20, v88, v89
    v_mfma_f32_16x16x32_bf16 v[108:111], v[240:243], v[48:51], 0
    ds_read_b128 v[228:231], v17 offset:0
    v_max3_f32 v20, v20, v90, v91
    v_mfma_f32_16x16x32_bf16 v[104:107], v[244:247], v[36:39], v[104:107]
    ds_read_b128 v[232:235], v18 offset:0
    v_max3_f32 v21, v21, v92, v93
    v_mfma_f32_16x16x32_bf16 v[108:111], v[244:247], v[52:55], v[108:111]
    ds_read_b128 v[236:239], v19 offset:0
    s_add_u32 m0, s46, 65536
    s_mov_b32 s57, 81920
    buffer_load_dwordx4 v6, s[28:31], s57 offen nt lds
    v_max3_f32 v21, v21, v94, v95
    v_mfma_f32_16x16x32_bf16 v[104:107], v[248:251], v[40:43], v[104:107]
    s_add_u32 m0, s46, 65536
    s_mov_b32 s57, 81920
    buffer_load_dwordx4 v6, s[28:31], s57 offen offset:2048 nt lds
    v_mfma_f32_16x16x32_bf16 v[108:111], v[248:251], v[56:59], v[108:111]
    s_add_u32 m0, s46, 66560
    s_mov_b32 s57, 81920
    buffer_load_dwordx4 v7, s[28:31], s57 offen nt lds
    v_mfma_f32_16x16x32_bf16 v[104:107], v[252:255], v[44:47], v[104:107]
    s_add_u32 m0, s46, 66560
    s_mov_b32 s57, 81920
    buffer_load_dwordx4 v7, s[28:31], s57 offen offset:2048 nt lds
    v_mfma_f32_16x16x32_bf16 v[108:111], v[252:255], v[60:63], v[108:111]
    s_add_u32 m0, s46, 118784
    s_mov_b32 s57, 98304
    buffer_load_dwordx4 v6, s[28:31], s57 offen nt lds
    s_cmp_eq_u32 s45, 0
    s_cbranch_scc0 .L36
    v_mfma_f32_16x16x32_bf16 v[220:223], v[240:243], v[64:67], 0
    v_mfma_f32_16x16x32_bf16 v[220:223], v[244:247], v[68:71], v[220:223]
    v_mfma_f32_16x16x32_bf16 v[220:223], v[248:251], v[72:75], v[220:223]
    v_mfma_f32_16x16x32_bf16 v[220:223], v[252:255], v[76:79], v[220:223]
.L36:
    s_waitcnt lgkmcnt(3)
    v_mfma_f32_16x16x32_bf16 v[112:115], v[224:227], v[32:35], 0
    ds_read_b128 v[240:243], v16 offset:4096
    v_max3_f32 v20, v20, v96, v97
    v_mfma_f32_16x16x32_bf16 v[116:119], v[224:227], v[48:51], 0
    ds_read_b128 v[244:247], v17 offset:4096
    v_max3_f32 v20, v20, v98, v99
    s_waitcnt lgkmcnt(4)
    v_mfma_f32_16x16x32_bf16 v[112:115], v[228:231], v[36:39], v[112:115]
    ds_read_b128 v[248:251], v18 offset:4096
    v_max3_f32 v21, v21, v100, v101
    v_mfma_f32_16x16x32_bf16 v[116:119], v[228:231], v[52:55], v[116:119]
    ds_read_b128 v[252:255], v19 offset:4096
    s_add_u32 m0, s46, 118784
    s_mov_b32 s57, 98304
    buffer_load_dwordx4 v6, s[28:31], s57 offen offset:2048 nt lds
    v_max3_f32 v21, v21, v102, v103
    s_waitcnt lgkmcnt(5)
    v_mfma_f32_16x16x32_bf16 v[112:115], v[232:235], v[40:43], v[112:115]
    s_add_u32 m0, s46, 119808
    s_mov_b32 s57, 98304
    buffer_load_dwordx4 v7, s[28:31], s57 offen nt lds
    v_mfma_f32_16x16x32_bf16 v[116:119], v[232:235], v[56:59], v[116:119]
    s_add_u32 m0, s46, 119808
    s_mov_b32 s57, 98304
    buffer_load_dwordx4 v7, s[28:31], s57 offen offset:2048 nt lds
    s_waitcnt lgkmcnt(4)
    v_mfma_f32_16x16x32_bf16 v[112:115], v[236:239], v[44:47], v[112:115]
    v_mfma_f32_16x16x32_bf16 v[116:119], v[236:239], v[60:63], v[116:119]
    s_cmp_eq_u32 s45, 1
    s_cbranch_scc0 .L37
    v_mfma_f32_16x16x32_bf16 v[208:211], v[224:227], v[64:67], 0
    v_mfma_f32_16x16x32_bf16 v[208:211], v[228:231], v[68:71], v[208:211]
    v_mfma_f32_16x16x32_bf16 v[208:211], v[232:235], v[72:75], v[208:211]
    v_mfma_f32_16x16x32_bf16 v[208:211], v[236:239], v[76:79], v[208:211]
.L37:
    s_waitcnt lgkmcnt(3)
    v_mfma_f32_16x16x32_bf16 v[120:123], v[240:243], v[32:35], 0
    ds_read_b128 v[224:227], v16 offset:8192
    v_max3_f32 v20, v20, v104, v105
    v_mfma_f32_16x16x32_bf16 v[124:127], v[240:243], v[48:51], 0
    ds_read_b128 v[228:231], v17 offset:8192
    v_max3_f32 v20, v20, v106, v107
    s_waitcnt lgkmcnt(4)
    v_mfma_f32_16x16x32_bf16 v[120:123], v[244:247], v[36:39], v[120:123]
    ds_read_b128 v[232:235], v18 offset:8192
    v_max3_f32 v21, v21, v108, v109
    v_mfma_f32_16x16x32_bf16 v[124:127], v[244:247], v[52:55], v[124:127]
    ds_read_b128 v[236:239], v19 offset:8192
    v_max3_f32 v21, v21, v110, v111
    s_waitcnt lgkmcnt(5)
    v_mfma_f32_16x16x32_bf16 v[120:123], v[248:251], v[40:43], v[120:123]
    v_mfma_f32_16x16x32_bf16 v[124:127], v[248:251], v[56:59], v[124:127]
    s_waitcnt lgkmcnt(4)
    v_mfma_f32_16x16x32_bf16 v[120:123], v[252:255], v[44:47], v[120:123]
    v_mfma_f32_16x16x32_bf16 v[124:127], v[252:255], v[60:63], v[124:127]
    s_cmp_eq_u32 s45, 1
    s_cbranch_scc0 .L38
    v_mfma_f32_16x16x32_bf16 v[212:215], v[240:243], v[64:67], 0
    v_mfma_f32_16x16x32_bf16 v[212:215], v[244:247], v[68:71], v[212:215]
    v_mfma_f32_16x16x32_bf16 v[212:215], v[248:251], v[72:75], v[212:215]
    v_mfma_f32_16x16x32_bf16 v[212:215], v[252:255], v[76:79], v[212:215]
.L38:
    s_waitcnt lgkmcnt(3)
    v_mfma_f32_16x16x32_bf16 v[128:131], v[224:227], v[32:35], 0
    ds_read_b128 v[240:243], v16 offset:12288
    v_max3_f32 v20, v20, v112, v113
    v_mfma_f32_16x16x32_bf16 v[132:135], v[224:227], v[48:51], 0
    ds_read_b128 v[244:247], v17 offset:12288
    v_max3_f32 v20, v20, v114, v115
    s_waitcnt lgkmcnt(4)
    v_mfma_f32_16x16x32_bf16 v[128:131], v[228:231], v[36:39], v[128:131]
    ds_read_b128 v[248:251], v18 offset:12288
    v_max3_f32 v21, v21, v116, v117
    v_mfma_f32_16x16x32_bf16 v[132:135], v[228:231], v[52:55], v[132:135]
    ds_read_b128 v[252:255], v19 offset:12288
    v_max3_f32 v21, v21, v118, v119
    s_waitcnt lgkmcnt(5)
    v_mfma_f32_16x16x32_bf16 v[128:131], v[232:235], v[40:43], v[128:131]
    v_mfma_f32_16x16x32_bf16 v[132:135], v[232:235], v[56:59], v[132:135]
    s_waitcnt lgkmcnt(4)
    v_mfma_f32_16x16x32_bf16 v[128:131], v[236:239], v[44:47], v[128:131]
    v_mfma_f32_16x16x32_bf16 v[132:135], v[236:239], v[60:63], v[132:135]
    s_cmp_eq_u32 s45, 1
    s_cbranch_scc0 .L39
    v_mfma_f32_16x16x32_bf16 v[216:219], v[224:227], v[64:67], 0
    v_mfma_f32_16x16x32_bf16 v[216:219], v[228:231], v[68:71], v[216:219]
    v_mfma_f32_16x16x32_bf16 v[216:219], v[232:235], v[72:75], v[216:219]
    v_mfma_f32_16x16x32_bf16 v[216:219], v[236:239], v[76:79], v[216:219]
.L39:
    s_waitcnt lgkmcnt(0)
    s_waitcnt vmcnt(20)
    s_barrier
    v_add_u32 v16, 0, v8
    v_add_u32 v17, 0, v9
    v_add_u32 v18, 0, v10
    v_add_u32 v19, 0, v11
    v_mfma_f32_16x16x32_bf16 v[136:139], v[240:243], v[32:35], 0
    ds_read_b128 v[224:227], v16 offset:0
    v_max3_f32 v20, v20, v120, v121
    v_mfma_f32_16x16x32_bf16 v[140:143], v[240:243], v[48:51], 0
    ds_read_b128 v[228:231], v17 offset:0
    v_max3_f32 v20, v20, v122, v123
    v_mfma_f32_16x16x32_bf16 v[136:139], v[244:247], v[36:39], v[136:139]
    ds_read_b128 v[232:235], v18 offset:0
    v_max3_f32 v21, v21, v124, v125
    v_mfma_f32_16x16x32_bf16 v[140:143], v[244:247], v[52:55], v[140:143]
    ds_read_b128 v[236:239], v19 offset:0
    s_add_u32 m0, s46, 135168
    s_mov_b32 s57, 114688
    buffer_load_dwordx4 v6, s[28:31], s57 offen nt lds
    v_max3_f32 v21, v21, v126, v127
    v_mfma_f32_16x16x32_bf16 v[136:139], v[248:251], v[40:43], v[136:139]
    s_add_u32 m0, s46, 135168
    s_mov_b32 s57, 114688
    buffer_load_dwordx4 v6, s[28:31], s57 offen offset:2048 nt lds
    v_mfma_f32_16x16x32_bf16 v[140:143], v[248:251], v[56:59], v[140:143]
    s_add_u32 m0, s46, 136192
    s_mov_b32 s57, 114688
    buffer_load_dwordx4 v7, s[28:31], s57 offen nt lds
    v_mfma_f32_16x16x32_bf16 v[136:139], v[252:255], v[44:47], v[136:139]
    s_add_u32 m0, s46, 136192
    s_mov_b32 s57, 114688
    buffer_load_dwordx4 v7, s[28:31], s57 offen offset:2048 nt lds
    v_mfma_f32_16x16x32_bf16 v[140:143], v[252:255], v[60:63], v[140:143]
    s_cmp_eq_u32 s45, 1
    s_cbranch_scc0 .L40
    v_mfma_f32_16x16x32_bf16 v[220:223], v[240:243], v[64:67], 0
    v_mfma_f32_16x16x32_bf16 v[220:223], v[244:247], v[68:71], v[220:223]
    v_mfma_f32_16x16x32_bf16 v[220:223], v[248:251], v[72:75], v[220:223]
    v_mfma_f32_16x16x32_bf16 v[220:223], v[252:255], v[76:79], v[220:223]
.L40:
    s_waitcnt lgkmcnt(3)
    v_mfma_f32_16x16x32_bf16 v[144:147], v[224:227], v[32:35], 0
    ds_read_b128 v[240:243], v16 offset:4096
    v_max3_f32 v20, v20, v128, v129
    v_mfma_f32_16x16x32_bf16 v[148:151], v[224:227], v[48:51], 0
    ds_read_b128 v[244:247], v17 offset:4096
    v_max3_f32 v20, v20, v130, v131
    s_waitcnt lgkmcnt(4)
    v_mfma_f32_16x16x32_bf16 v[144:147], v[228:231], v[36:39], v[144:147]
    ds_read_b128 v[248:251], v18 offset:4096
    v_max3_f32 v21, v21, v132, v133
    v_mfma_f32_16x16x32_bf16 v[148:151], v[228:231], v[52:55], v[148:151]
    ds_read_b128 v[252:255], v19 offset:4096
    v_max3_f32 v21, v21, v134, v135
    s_waitcnt lgkmcnt(5)
    v_mfma_f32_16x16x32_bf16 v[144:147], v[232:235], v[40:43], v[144:147]
    v_mfma_f32_16x16x32_bf16 v[148:151], v[232:235], v[56:59], v[148:151]
    s_waitcnt lgkmcnt(4)
    v_mfma_f32_16x16x32_bf16 v[144:147], v[236:239], v[44:47], v[144:147]
    v_mfma_f32_16x16x32_bf16 v[148:151], v[236:239], v[60:63], v[148:151]
    s_cmp_eq_u32 s45, 2
    s_cbranch_scc0 .L41
    v_mfma_f32_16x16x32_bf16 v[208:211], v[224:227], v[64:67], 0
    v_mfma_f32_16x16x32_bf16 v[208:211], v[228:231], v[68:71], v[208:211]
    v_mfma_f32_16x16x32_bf16 v[208:211], v[232:235], v[72:75], v[208:211]
    v_mfma_f32_16x16x32_bf16 v[208:211], v[236:239], v[76:79], v[208:211]
.L41:
    s_waitcnt lgkmcnt(3)
    v_mfma_f32_16x16x32_bf16 v[152:155], v[240:243], v[32:35], 0
    ds_read_b128 v[224:227], v16 offset:8192
    v_max3_f32 v20, v20, v136, v137
    v_mfma_f32_16x16x32_bf16 v[156:159], v[240:243], v[48:51], 0
    ds_read_b128 v[228:231], v17 offset:8192
    v_max3_f32 v20, v20, v138, v139
    s_waitcnt lgkmcnt(4)
    v_mfma_f32_16x16x32_bf16 v[152:155], v[244:247], v[36:39], v[152:155]
    ds_read_b128 v[232:235], v18 offset:8192
    v_max3_f32 v21, v21, v140, v141
    v_mfma_f32_16x16x32_bf16 v[156:159], v[244:247], v[52:55], v[156:159]
    ds_read_b128 v[236:239], v19 offset:8192
    v_max3_f32 v21, v21, v142, v143
    s_waitcnt lgkmcnt(5)
    v_mfma_f32_16x16x32_bf16 v[152:155], v[248:251], v[40:43], v[152:155]
    v_mfma_f32_16x16x32_bf16 v[156:159], v[248:251], v[56:59], v[156:159]
    s_waitcnt lgkmcnt(4)
    v_mfma_f32_16x16x32_bf16 v[152:155], v[252:255], v[44:47], v[152:155]
    v_mfma_f32_16x16x32_bf16 v[156:159], v[252:255], v[60:63], v[156:159]
    s_cmp_eq_u32 s45, 2
    s_cbranch_scc0 .L42
    v_mfma_f32_16x16x32_bf16 v[212:215], v[240:243], v[64:67], 0
    v_mfma_f32_16x16x32_bf16 v[212:215], v[244:247], v[68:71], v[212:215]
    v_mfma_f32_16x16x32_bf16 v[212:215], v[248:251], v[72:75], v[212:215]
    v_mfma_f32_16x16x32_bf16 v[212:215], v[252:255], v[76:79], v[212:215]
.L42:
    s_waitcnt lgkmcnt(3)
    v_mfma_f32_16x16x32_bf16 v[160:163], v[224:227], v[32:35], 0
    ds_read_b128 v[240:243], v16 offset:12288
    v_max3_f32 v20, v20, v144, v145
    v_mfma_f32_16x16x32_bf16 v[164:167], v[224:227], v[48:51], 0
    ds_read_b128 v[244:247], v17 offset:12288
    v_max3_f32 v20, v20, v146, v147
    s_waitcnt lgkmcnt(4)
    v_mfma_f32_16x16x32_bf16 v[160:163], v[228:231], v[36:39], v[160:163]
    ds_read_b128 v[248:251], v18 offset:12288
    v_max3_f32 v21, v21, v148, v149
    v_mfma_f32_16x16x32_bf16 v[164:167], v[228:231], v[52:55], v[164:167]
    ds_read_b128 v[252:255], v19 offset:12288
    v_max3_f32 v21, v21, v150, v151
    s_waitcnt lgkmcnt(5)
    v_mfma_f32_16x16x32_bf16 v[160:163], v[232:235], v[40:43], v[160:163]
    v_mfma_f32_16x16x32_bf16 v[164:167], v[232:235], v[56:59], v[164:167]
    s_waitcnt lgkmcnt(4)
    v_mfma_f32_16x16x32_bf16 v[160:163], v[236:239], v[44:47], v[160:163]
    v_mfma_f32_16x16x32_bf16 v[164:167], v[236:239], v[60:63], v[164:167]
    s_cmp_eq_u32 s45, 2
    s_cbranch_scc0 .L43
    v_mfma_f32_16x16x32_bf16 v[216:219], v[224:227], v[64:67], 0
    v_mfma_f32_16x16x32_bf16 v[216:219], v[228:231], v[68:71], v[216:219]
    v_mfma_f32_16x16x32_bf16 v[216:219], v[232:235], v[72:75], v[216:219]
    v_mfma_f32_16x16x32_bf16 v[216:219], v[236:239], v[76:79], v[216:219]
.L43:
    s_waitcnt lgkmcnt(0)
    s_waitcnt vmcnt(16)
    s_barrier
    v_add_u32 v16, 32768, v8
    v_add_u32 v17, 32768, v9
    v_add_u32 v18, 32768, v10
    v_add_u32 v19, 32768, v11
    v_mfma_f32_16x16x32_bf16 v[168:171], v[240:243], v[32:35], 0
    ds_read_b128 v[224:227], v16 offset:0
    v_max3_f32 v20, v20, v152, v153
    v_mfma_f32_16x16x32_bf16 v[172:175], v[240:243], v[48:51], 0
    ds_read_b128 v[228:231], v17 offset:0
    v_max3_f32 v20, v20, v154, v155
    v_mfma_f32_16x16x32_bf16 v[168:171], v[244:247], v[36:39], v[168:171]
    ds_read_b128 v[232:235], v18 offset:0
    v_max3_f32 v21, v21, v156, v157
    v_mfma_f32_16x16x32_bf16 v[172:175], v[244:247], v[52:55], v[172:175]
    ds_read_b128 v[236:239], v19 offset:0
    v_max3_f32 v21, v21, v158, v159
    v_mfma_f32_16x16x32_bf16 v[168:171], v[248:251], v[40:43], v[168:171]
    v_mfma_f32_16x16x32_bf16 v[172:175], v[248:251], v[56:59], v[172:175]
    v_mfma_f32_16x16x32_bf16 v[168:171], v[252:255], v[44:47], v[168:171]
    v_mfma_f32_16x16x32_bf16 v[172:175], v[252:255], v[60:63], v[172:175]
    s_cmp_eq_u32 s45, 2
    s_cbranch_scc0 .L44
    v_mfma_f32_16x16x32_bf16 v[220:223], v[240:243], v[64:67], 0
    v_mfma_f32_16x16x32_bf16 v[220:223], v[244:247], v[68:71], v[220:223]
    v_mfma_f32_16x16x32_bf16 v[220:223], v[248:251], v[72:75], v[220:223]
    v_mfma_f32_16x16x32_bf16 v[220:223], v[252:255], v[76:79], v[220:223]
.L44:
    s_waitcnt lgkmcnt(3)
    v_mfma_f32_16x16x32_bf16 v[176:179], v[224:227], v[32:35], 0
    ds_read_b128 v[240:243], v16 offset:4096
    v_max3_f32 v20, v20, v160, v161
    v_mfma_f32_16x16x32_bf16 v[180:183], v[224:227], v[48:51], 0
    ds_read_b128 v[244:247], v17 offset:4096
    v_max3_f32 v20, v20, v162, v163
    s_waitcnt lgkmcnt(4)
    v_mfma_f32_16x16x32_bf16 v[176:179], v[228:231], v[36:39], v[176:179]
    ds_read_b128 v[248:251], v18 offset:4096
    v_max3_f32 v21, v21, v164, v165
    v_mfma_f32_16x16x32_bf16 v[180:183], v[228:231], v[52:55], v[180:183]
    ds_read_b128 v[252:255], v19 offset:4096
    v_max3_f32 v21, v21, v166, v167
    s_waitcnt lgkmcnt(5)
    v_mfma_f32_16x16x32_bf16 v[176:179], v[232:235], v[40:43], v[176:179]
    v_mfma_f32_16x16x32_bf16 v[180:183], v[232:235], v[56:59], v[180:183]
    s_waitcnt lgkmcnt(4)
    v_mfma_f32_16x16x32_bf16 v[176:179], v[236:239], v[44:47], v[176:179]
    v_mfma_f32_16x16x32_bf16 v[180:183], v[236:239], v[60:63], v[180:183]
    s_cmp_eq_u32 s45, 3
    s_cbranch_scc0 .L45
    v_mfma_f32_16x16x32_bf16 v[208:211], v[224:227], v[64:67], 0
    v_mfma_f32_16x16x32_bf16 v[208:211], v[228:231], v[68:71], v[208:211]
    v_mfma_f32_16x16x32_bf16 v[208:211], v[232:235], v[72:75], v[208:211]
    v_mfma_f32_16x16x32_bf16 v[208:211], v[236:239], v[76:79], v[208:211]
.L45:
    s_waitcnt lgkmcnt(3)
    v_mfma_f32_16x16x32_bf16 v[184:187], v[240:243], v[32:35], 0
    ds_read_b128 v[224:227], v16 offset:8192
    v_max3_f32 v20, v20, v168, v169
    v_mfma_f32_16x16x32_bf16 v[188:191], v[240:243], v[48:51], 0
    ds_read_b128 v[228:231], v17 offset:8192
    v_max3_f32 v20, v20, v170, v171
    s_waitcnt lgkmcnt(4)
    v_mfma_f32_16x16x32_bf16 v[184:187], v[244:247], v[36:39], v[184:187]
    ds_read_b128 v[232:235], v18 offset:8192
    v_max3_f32 v21, v21, v172, v173
    v_mfma_f32_16x16x32_bf16 v[188:191], v[244:247], v[52:55], v[188:191]
    ds_read_b128 v[236:239], v19 offset:8192
    v_max3_f32 v21, v21, v174, v175
    s_waitcnt lgkmcnt(5)
    v_mfma_f32_16x16x32_bf16 v[184:187], v[248:251], v[40:43], v[184:187]
    v_mfma_f32_16x16x32_bf16 v[188:191], v[248:251], v[56:59], v[188:191]
    s_waitcnt lgkmcnt(4)
    v_mfma_f32_16x16x32_bf16 v[184:187], v[252:255], v[44:47], v[184:187]
    v_mfma_f32_16x16x32_bf16 v[188:191], v[252:255], v[60:63], v[188:191]
    s_cmp_eq_u32 s45, 3
    s_cbranch_scc0 .L46
    v_mfma_f32_16x16x32_bf16 v[212:215], v[240:243], v[64:67], 0
    v_mfma_f32_16x16x32_bf16 v[212:215], v[244:247], v[68:71], v[212:215]
    v_mfma_f32_16x16x32_bf16 v[212:215], v[248:251], v[72:75], v[212:215]
    v_mfma_f32_16x16x32_bf16 v[212:215], v[252:255], v[76:79], v[212:215]
.L46:
    s_waitcnt lgkmcnt(3)
    v_mfma_f32_16x16x32_bf16 v[192:195], v[224:227], v[32:35], 0
    ds_read_b128 v[240:243], v16 offset:12288
    v_max3_f32 v20, v20, v176, v177
    v_mfma_f32_16x16x32_bf16 v[196:199], v[224:227], v[48:51], 0
    ds_read_b128 v[244:247], v17 offset:12288
    v_max3_f32 v20, v20, v178, v179
    s_waitcnt lgkmcnt(4)
    v_mfma_f32_16x16x32_bf16 v[192:195], v[228:231], v[36:39], v[192:195]
    ds_read_b128 v[248:251], v18 offset:12288
    v_max3_f32 v21, v21, v180, v181
    v_mfma_f32_16x16x32_bf16 v[196:199], v[228:231], v[52:55], v[196:199]
    ds_read_b128 v[252:255], v19 offset:12288
    v_max3_f32 v21, v21, v182, v183
    s_waitcnt lgkmcnt(5)
    v_mfma_f32_16x16x32_bf16 v[192:195], v[232:235], v[40:43], v[192:195]
    v_mfma_f32_16x16x32_bf16 v[196:199], v[232:235], v[56:59], v[196:199]
    s_waitcnt lgkmcnt(4)
    v_mfma_f32_16x16x32_bf16 v[192:195], v[236:239], v[44:47], v[192:195]
    v_mfma_f32_16x16x32_bf16 v[196:199], v[236:239], v[60:63], v[196:199]
    s_cmp_eq_u32 s45, 3
    s_cbranch_scc0 .L47
    v_mfma_f32_16x16x32_bf16 v[216:219], v[224:227], v[64:67], 0
    v_mfma_f32_16x16x32_bf16 v[216:219], v[228:231], v[68:71], v[216:219]
    v_mfma_f32_16x16x32_bf16 v[216:219], v[232:235], v[72:75], v[216:219]
    v_mfma_f32_16x16x32_bf16 v[216:219], v[236:239], v[76:79], v[216:219]
.L47:
    s_waitcnt lgkmcnt(3)
    v_mfma_f32_16x16x32_bf16 v[200:203], v[240:243], v[32:35], 0
    v_max3_f32 v20, v20, v184, v185
    v_mfma_f32_16x16x32_bf16 v[204:207], v[240:243], v[48:51], 0
    v_max3_f32 v20, v20, v186, v187
    s_waitcnt lgkmcnt(2)
    v_mfma_f32_16x16x32_bf16 v[200:203], v[244:247], v[36:39], v[200:203]
    v_max3_f32 v21, v21, v188, v189
    v_mfma_f32_16x16x32_bf16 v[204:207], v[244:247], v[52:55], v[204:207]
    v_max3_f32 v21, v21, v190, v191
    s_waitcnt lgkmcnt(1)
    v_mfma_f32_16x16x32_bf16 v[200:203], v[248:251], v[40:43], v[200:203]
    v_mfma_f32_16x16x32_bf16 v[204:207], v[248:251], v[56:59], v[204:207]
    s_waitcnt lgkmcnt(0)
    v_mfma_f32_16x16x32_bf16 v[200:203], v[252:255], v[44:47], v[200:203]
    v_mfma_f32_16x16x32_bf16 v[204:207], v[252:255], v[60:63], v[204:207]
    s_cmp_eq_u32 s45, 3
    s_cbranch_scc0 .L48
    v_mfma_f32_16x16x32_bf16 v[220:223], v[240:243], v[64:67], 0
    v_mfma_f32_16x16x32_bf16 v[220:223], v[244:247], v[68:71], v[220:223]
    v_mfma_f32_16x16x32_bf16 v[220:223], v[248:251], v[72:75], v[220:223]
    v_mfma_f32_16x16x32_bf16 v[220:223], v[252:255], v[76:79], v[220:223]
.L48:
    s_waitcnt lgkmcnt(0)
    s_barrier
    s_mov_b32 s53, 0x3e0293ee
    v_mov_b32 v14, s53
    v_mov_b32 v15, s53
    v_max3_f32 v20, v20, v192, v193
    v_max3_f32 v20, v20, v194, v195
    v_max3_f32 v21, v21, v196, v197
    v_max3_f32 v21, v21, v198, v199
    v_max3_f32 v20, v20, v200, v201
    v_max3_f32 v20, v20, v202, v203
    v_max3_f32 v21, v21, v204, v205
    v_max3_f32 v21, v21, v206, v207
    v_max3_f32 v22, v208, v209, v210
    v_max3_f32 v22, v22, v211, v212
    v_max3_f32 v22, v22, v213, v214
    v_max3_f32 v22, v22, v215, v216
    v_max3_f32 v22, v22, v217, v218
    v_max3_f32 v22, v22, v219, v220
    v_max3_f32 v22, v22, v221, v222
    v_max_f32 v22, v22, v223
    v_mov_b32 v23, v20
    v_mov_b32 v24, v21
    v_mov_b32 v25, v22
    s_nop 1
    v_permlane32_swap_b32 v20, v23
    v_permlane32_swap_b32 v21, v24
    v_permlane32_swap_b32 v22, v25
    v_max_f32 v20, v20, v23
    v_max_f32 v21, v21, v24
    v_max_f32 v22, v22, v25
    v_mov_b32 v23, v20
    v_mov_b32 v24, v21
    v_mov_b32 v25, v22
    s_nop 1
    v_permlane16_swap_b32 v20, v23
    v_permlane16_swap_b32 v21, v24
    v_permlane16_swap_b32 v22, v25
    v_max_f32 v20, v20, v23
    v_max_f32 v21, v21, v24
    v_max_f32 v22, v22, v25
    v_mul_f32 v248, s53, v20
    v_sub_f32 v248, 0, v248
    v_mov_b32 v249, v248
    v_mul_f32 v250, s53, v21
    v_sub_f32 v250, 0, v250
    v_mov_b32 v251, v250
    v_mul_f32 v252, s53, v22
    v_sub_f32 v252, 0, v252
    v_mov_b32 v253, v252
    v_pk_fma_f32 v[208:209], v[208:209], v[14:15], v[252:253]
    v_pk_fma_f32 v[210:211], v[210:211], v[14:15], v[252:253]
    v_pk_fma_f32 v[212:213], v[212:213], v[14:15], v[252:253]
    v_pk_fma_f32 v[214:215], v[214:215], v[14:15], v[252:253]
    v_pk_fma_f32 v[216:217], v[216:217], v[14:15], v[252:253]
    v_pk_fma_f32 v[218:219], v[218:219], v[14:15], v[252:253]
    v_pk_fma_f32 v[220:221], v[220:221], v[14:15], v[252:253]
    v_pk_fma_f32 v[222:223], v[222:223], v[14:15], v[252:253]
    v_exp_f32 v208, v208
    v_exp_f32 v209, v209
    v_exp_f32 v210, v210
    v_exp_f32 v211, v211
    v_exp_f32 v212, v212
    v_exp_f32 v213, v213
    v_exp_f32 v214, v214
    v_exp_f32 v215, v215
    v_exp_f32 v216, v216
    v_exp_f32 v217, v217
    v_exp_f32 v218, v218
    v_exp_f32 v219, v219
    v_exp_f32 v220, v220
    v_exp_f32 v221, v221
    v_exp_f32 v222, v222
    v_exp_f32 v223, v223
    s_nop 0
    v_cvt_pk_bf16_f32 v208, v208, v209
    v_cvt_pk_bf16_f32 v209, v210, v211
    v_cvt_pk_bf16_f32 v210, v212, v213
    v_cvt_pk_bf16_f32 v211, v214, v215
    v_cvt_pk_bf16_f32 v212, v216, v217
    v_cvt_pk_bf16_f32 v213, v218, v219
    v_cvt_pk_bf16_f32 v214, v220, v221
    v_cvt_pk_bf16_f32 v215, v222, v223
    v_pk_fma_f32 v[80:81], v[80:81], v[14:15], v[248:249]
    v_pk_fma_f32 v[82:83], v[82:83], v[14:15], v[248:249]
    v_pk_fma_f32 v[88:89], v[88:89], v[14:15], v[248:249]
    v_pk_fma_f32 v[90:91], v[90:91], v[14:15], v[248:249]
    v_exp_f32 v80, v80
    v_exp_f32 v81, v81
    v_exp_f32 v82, v82
    v_exp_f32 v83, v83
    v_exp_f32 v88, v88
    v_exp_f32 v89, v89
    v_exp_f32 v90, v90
    v_exp_f32 v91, v91
    s_nop 0
    v_cvt_pk_bf16_f32 v32, v80, v81
    v_cvt_pk_bf16_f32 v33, v82, v83
    v_cvt_pk_bf16_f32 v34, v88, v89
    v_cvt_pk_bf16_f32 v35, v90, v91
    v_pk_fma_f32 v[84:85], v[84:85], v[14:15], v[250:251]
    v_pk_fma_f32 v[86:87], v[86:87], v[14:15], v[250:251]
    v_pk_fma_f32 v[92:93], v[92:93], v[14:15], v[250:251]
    v_pk_fma_f32 v[94:95], v[94:95], v[14:15], v[250:251]
    v_exp_f32 v84, v84
    v_exp_f32 v85, v85
    v_exp_f32 v86, v86
    v_exp_f32 v87, v87
    v_exp_f32 v92, v92
    v_exp_f32 v93, v93
    v_exp_f32 v94, v94
    v_exp_f32 v95, v95
    s_nop 0
    v_cvt_pk_bf16_f32 v36, v84, v85
    v_cvt_pk_bf16_f32 v37, v86, v87
    v_cvt_pk_bf16_f32 v38, v92, v93
    v_cvt_pk_bf16_f32 v39, v94, v95
    v_pk_fma_f32 v[96:97], v[96:97], v[14:15], v[248:249]
    v_pk_fma_f32 v[98:99], v[98:99], v[14:15], v[248:249]
    v_pk_fma_f32 v[104:105], v[104:105], v[14:15], v[248:249]
    v_pk_fma_f32 v[106:107], v[106:107], v[14:15], v[248:249]
    v_exp_f32 v96, v96
    v_exp_f32 v97, v97
    v_exp_f32 v98, v98
    v_exp_f32 v99, v99
    v_exp_f32 v104, v104
    v_exp_f32 v105, v105
    v_exp_f32 v106, v106
    v_exp_f32 v107, v107
    s_nop 0
    v_cvt_pk_bf16_f32 v40, v96, v97
    v_cvt_pk_bf16_f32 v41, v98, v99
    v_cvt_pk_bf16_f32 v42, v104, v105
    v_cvt_pk_bf16_f32 v43, v106, v107
    v_pk_fma_f32 v[100:101], v[100:101], v[14:15], v[250:251]
    v_pk_fma_f32 v[102:103], v[102:103], v[14:15], v[250:251]
    v_pk_fma_f32 v[108:109], v[108:109], v[14:15], v[250:251]
    v_pk_fma_f32 v[110:111], v[110:111], v[14:15], v[250:251]
    v_exp_f32 v100, v100
    v_exp_f32 v101, v101
    v_exp_f32 v102, v102
    v_exp_f32 v103, v103
    v_exp_f32 v108, v108
    v_exp_f32 v109, v109
    v_exp_f32 v110, v110
    v_exp_f32 v111, v111
    s_nop 0
    v_cvt_pk_bf16_f32 v44, v100, v101
    v_cvt_pk_bf16_f32 v45, v102, v103
    v_cvt_pk_bf16_f32 v46, v108, v109
    v_cvt_pk_bf16_f32 v47, v110, v111
    v_pk_fma_f32 v[112:113], v[112:113], v[14:15], v[248:249]
    v_pk_fma_f32 v[114:115], v[114:115], v[14:15], v[248:249]
    v_pk_fma_f32 v[120:121], v[120:121], v[14:15], v[248:249]
    v_pk_fma_f32 v[122:123], v[122:123], v[14:15], v[248:249]
    v_exp_f32 v112, v112
    v_exp_f32 v113, v113
    v_exp_f32 v114, v114
    v_exp_f32 v115, v115
    v_exp_f32 v120, v120
    v_exp_f32 v121, v121
    v_exp_f32 v122, v122
    v_exp_f32 v123, v123
    s_nop 0
    v_cvt_pk_bf16_f32 v48, v112, v113
    v_cvt_pk_bf16_f32 v49, v114, v115
    v_cvt_pk_bf16_f32 v50, v120, v121
    v_cvt_pk_bf16_f32 v51, v122, v123
    v_pk_fma_f32 v[116:117], v[116:117], v[14:15], v[250:251]
    v_pk_fma_f32 v[118:119], v[118:119], v[14:15], v[250:251]
    v_pk_fma_f32 v[124:125], v[124:125], v[14:15], v[250:251]
    v_pk_fma_f32 v[126:127], v[126:127], v[14:15], v[250:251]
    v_exp_f32 v116, v116
    v_exp_f32 v117, v117
    v_exp_f32 v118, v118
    v_exp_f32 v119, v119
    v_exp_f32 v124, v124
    v_exp_f32 v125, v125
    v_exp_f32 v126, v126
    v_exp_f32 v127, v127
    s_nop 0
    v_cvt_pk_bf16_f32 v52, v116, v117
    v_cvt_pk_bf16_f32 v53, v118, v119
    v_cvt_pk_bf16_f32 v54, v124, v125
    v_cvt_pk_bf16_f32 v55, v126, v127
    v_pk_fma_f32 v[128:129], v[128:129], v[14:15], v[248:249]
    v_pk_fma_f32 v[130:131], v[130:131], v[14:15], v[248:249]
    v_pk_fma_f32 v[136:137], v[136:137], v[14:15], v[248:249]
    v_pk_fma_f32 v[138:139], v[138:139], v[14:15], v[248:249]
    v_exp_f32 v128, v128
    v_exp_f32 v129, v129
    v_exp_f32 v130, v130
    v_exp_f32 v131, v131
    v_exp_f32 v136, v136
    v_exp_f32 v137, v137
    v_exp_f32 v138, v138
    v_exp_f32 v139, v139
    s_nop 0
    v_cvt_pk_bf16_f32 v56, v128, v129
    v_cvt_pk_bf16_f32 v57, v130, v131
    v_cvt_pk_bf16_f32 v58, v136, v137
    v_cvt_pk_bf16_f32 v59, v138, v139
    v_pk_fma_f32 v[132:133], v[132:133], v[14:15], v[250:251]
    v_pk_fma_f32 v[134:135], v[134:135], v[14:15], v[250:251]
    v_pk_fma_f32 v[140:141], v[140:141], v[14:15], v[250:251]
    v_pk_fma_f32 v[142:143], v[142:143], v[14:15], v[250:251]
    v_exp_f32 v132, v132
    v_exp_f32 v133, v133
    v_exp_f32 v134, v134
    v_exp_f32 v135, v135
    v_exp_f32 v140, v140
    v_exp_f32 v141, v141
    v_exp_f32 v142, v142
    v_exp_f32 v143, v143
    s_nop 0
    v_cvt_pk_bf16_f32 v60, v132, v133
    v_cvt_pk_bf16_f32 v61, v134, v135
    v_cvt_pk_bf16_f32 v62, v140, v141
    v_cvt_pk_bf16_f32 v63, v142, v143
    s_barrier
    v_pk_fma_f32 v[144:145], v[144:145], v[14:15], v[248:249]
    v_pk_fma_f32 v[146:147], v[146:147], v[14:15], v[248:249]
    v_pk_fma_f32 v[152:153], v[152:153], v[14:15], v[248:249]
    v_pk_fma_f32 v[154:155], v[154:155], v[14:15], v[248:249]
    v_exp_f32 v144, v144
    v_exp_f32 v145, v145
    v_exp_f32 v146, v146
    v_exp_f32 v147, v147
    v_exp_f32 v152, v152
    v_exp_f32 v153, v153
    v_exp_f32 v154, v154
    v_exp_f32 v155, v155
    s_nop 0
    v_cvt_pk_bf16_f32 v64, v144, v145
    v_cvt_pk_bf16_f32 v65, v146, v147
    v_cvt_pk_bf16_f32 v66, v152, v153
    v_cvt_pk_bf16_f32 v67, v154, v155
    v_pk_fma_f32 v[148:149], v[148:149], v[14:15], v[250:251]
    v_pk_fma_f32 v[150:151], v[150:151], v[14:15], v[250:251]
    v_pk_fma_f32 v[156:157], v[156:157], v[14:15], v[250:251]
    v_pk_fma_f32 v[158:159], v[158:159], v[14:15], v[250:251]
    v_exp_f32 v148, v148
    v_exp_f32 v149, v149
    v_exp_f32 v150, v150
    v_exp_f32 v151, v151
    v_exp_f32 v156, v156
    v_exp_f32 v157, v157
    v_exp_f32 v158, v158
    v_exp_f32 v159, v159
    s_nop 0
    v_cvt_pk_bf16_f32 v68, v148, v149
    v_cvt_pk_bf16_f32 v69, v150, v151
    v_cvt_pk_bf16_f32 v70, v156, v157
    v_cvt_pk_bf16_f32 v71, v158, v159
    v_pk_fma_f32 v[160:161], v[160:161], v[14:15], v[248:249]
    v_pk_fma_f32 v[162:163], v[162:163], v[14:15], v[248:249]
    v_pk_fma_f32 v[168:169], v[168:169], v[14:15], v[248:249]
    v_pk_fma_f32 v[170:171], v[170:171], v[14:15], v[248:249]
    v_exp_f32 v160, v160
    v_exp_f32 v161, v161
    v_exp_f32 v162, v162
    v_exp_f32 v163, v163
    v_exp_f32 v168, v168
    v_exp_f32 v169, v169
    v_exp_f32 v170, v170
    v_exp_f32 v171, v171
    s_nop 0
    v_cvt_pk_bf16_f32 v72, v160, v161
    v_cvt_pk_bf16_f32 v73, v162, v163
    v_cvt_pk_bf16_f32 v74, v168, v169
    v_cvt_pk_bf16_f32 v75, v170, v171
    v_pk_fma_f32 v[164:165], v[164:165], v[14:15], v[250:251]
    v_pk_fma_f32 v[166:167], v[166:167], v[14:15], v[250:251]
    v_pk_fma_f32 v[172:173], v[172:173], v[14:15], v[250:251]
    v_pk_fma_f32 v[174:175], v[174:175], v[14:15], v[250:251]
    v_exp_f32 v164, v164
    v_exp_f32 v165, v165
    v_exp_f32 v166, v166
    v_exp_f32 v167, v167
    v_exp_f32 v172, v172
    v_exp_f32 v173, v173
    v_exp_f32 v174, v174
    v_exp_f32 v175, v175
    s_nop 0
    v_cvt_pk_bf16_f32 v76, v164, v165
    v_cvt_pk_bf16_f32 v77, v166, v167
    v_cvt_pk_bf16_f32 v78, v172, v173
    v_cvt_pk_bf16_f32 v79, v174, v175
    v_pk_fma_f32 v[176:177], v[176:177], v[14:15], v[248:249]
    v_pk_fma_f32 v[178:179], v[178:179], v[14:15], v[248:249]
    v_pk_fma_f32 v[184:185], v[184:185], v[14:15], v[248:249]
    v_pk_fma_f32 v[186:187], v[186:187], v[14:15], v[248:249]
    v_exp_f32 v176, v176
    v_exp_f32 v177, v177
    v_exp_f32 v178, v178
    v_exp_f32 v179, v179
    v_exp_f32 v184, v184
    v_exp_f32 v185, v185
    v_exp_f32 v186, v186
    v_exp_f32 v187, v187
    s_nop 0
    v_cvt_pk_bf16_f32 v224, v176, v177
    v_cvt_pk_bf16_f32 v225, v178, v179
    v_cvt_pk_bf16_f32 v226, v184, v185
    v_cvt_pk_bf16_f32 v227, v186, v187
    v_pk_fma_f32 v[180:181], v[180:181], v[14:15], v[250:251]
    v_pk_fma_f32 v[182:183], v[182:183], v[14:15], v[250:251]
    v_pk_fma_f32 v[188:189], v[188:189], v[14:15], v[250:251]
    v_pk_fma_f32 v[190:191], v[190:191], v[14:15], v[250:251]
    v_exp_f32 v180, v180
    v_exp_f32 v181, v181
    v_exp_f32 v182, v182
    v_exp_f32 v183, v183
    v_exp_f32 v188, v188
    v_exp_f32 v189, v189
    v_exp_f32 v190, v190
    v_exp_f32 v191, v191
    s_nop 0
    v_cvt_pk_bf16_f32 v228, v180, v181
    v_cvt_pk_bf16_f32 v229, v182, v183
    v_cvt_pk_bf16_f32 v230, v188, v189
    v_cvt_pk_bf16_f32 v231, v190, v191
    v_pk_fma_f32 v[192:193], v[192:193], v[14:15], v[248:249]
    v_pk_fma_f32 v[194:195], v[194:195], v[14:15], v[248:249]
    v_pk_fma_f32 v[200:201], v[200:201], v[14:15], v[248:249]
    v_pk_fma_f32 v[202:203], v[202:203], v[14:15], v[248:249]
    v_exp_f32 v192, v192
    v_exp_f32 v193, v193
    v_exp_f32 v194, v194
    v_exp_f32 v195, v195
    v_exp_f32 v200, v200
    v_exp_f32 v201, v201
    v_exp_f32 v202, v202
    v_exp_f32 v203, v203
    s_nop 0
    v_cvt_pk_bf16_f32 v232, v192, v193
    v_cvt_pk_bf16_f32 v233, v194, v195
    v_cvt_pk_bf16_f32 v234, v200, v201
    v_cvt_pk_bf16_f32 v235, v202, v203
    v_pk_fma_f32 v[196:197], v[196:197], v[14:15], v[250:251]
    v_pk_fma_f32 v[198:199], v[198:199], v[14:15], v[250:251]
    v_pk_fma_f32 v[204:205], v[204:205], v[14:15], v[250:251]
    v_pk_fma_f32 v[206:207], v[206:207], v[14:15], v[250:251]
    v_exp_f32 v196, v196
    v_exp_f32 v197, v197
    v_exp_f32 v198, v198
    v_exp_f32 v199, v199
    v_exp_f32 v204, v204
    v_exp_f32 v205, v205
    v_exp_f32 v206, v206
    v_exp_f32 v207, v207
    s_nop 0
    v_cvt_pk_bf16_f32 v236, v196, v197
    v_cvt_pk_bf16_f32 v237, v198, v199
    v_cvt_pk_bf16_f32 v238, v204, v205
    v_cvt_pk_bf16_f32 v239, v206, v207
    v_mov_b32 v240, v208
    v_mov_b32 v241, v209
    v_mov_b32 v242, v210
    v_mov_b32 v243, v211
    v_mov_b32 v244, v212
    v_mov_b32 v245, v213
    v_mov_b32 v246, v214
    v_mov_b32 v247, v215
    v_lshl_add_u32 v1, v28, 2, v29
    v_lshlrev_b32 v1, 8, v1
    v_lshl_add_u32 v1, v30, 3, v1
    v_xor_b32 v8, 0, v31
    v_lshl_add_u32 v8, v8, 5, v1
    v_xor_b32 v9, 1, v31
    v_lshl_add_u32 v9, v9, 5, v1
    v_xor_b32 v10, 2, v31
    v_lshl_add_u32 v10, v10, 5, v1
    v_xor_b32 v11, 3, v31
    v_lshl_add_u32 v11, v11, 5, v1
    v_xor_b32 v12, 4, v31
    v_lshl_add_u32 v12, v12, 5, v1
    v_xor_b32 v13, 5, v31
    v_lshl_add_u32 v13, v13, 5, v1
    v_xor_b32 v14, 6, v31
    v_lshl_add_u32 v14, v14, 5, v1
    v_xor_b32 v15, 7, v31
    v_lshl_add_u32 v15, v15, 5, v1
    v_mov_b32 v28, 0x3f803f80
    v_mov_b32 v29, 0x3f803f80
    v_mov_b32 v30, 0x3f803f80
    v_mov_b32 v31, 0x3f803f80
    s_waitcnt vmcnt(12)
    s_barrier
    v_add_u32 v16, 49152, v8
    v_add_u32 v17, 49152, v9
    v_add_u32 v18, 49152, v10
    v_add_u32 v19, 49152, v11
    v_add_u32 v20, 49152, v12
    v_add_u32 v21, 49152, v13
    v_add_u32 v22, 49152, v14
    v_add_u32 v23, 49152, v15
    ds_read_b64_tr_b16 v[188:189], v16 offset:0
    ds_read_b64_tr_b16 v[190:191], v16 offset:4096
    ds_read_b64_tr_b16 v[192:193], v17 offset:0
    ds_read_b64_tr_b16 v[194:195], v17 offset:4096
    ds_read_b64_tr_b16 v[196:197], v18 offset:0
    ds_read_b64_tr_b16 v[198:199], v18 offset:4096
    ds_read_b64_tr_b16 v[200:201], v19 offset:0
    ds_read_b64_tr_b16 v[202:203], v19 offset:4096
    s_waitcnt lgkmcnt(6)
    v_mfma_f32_16x16x32_bf16 v[80:83], v[188:191], v[32:35], 0
    ds_read_b64_tr_b16 v[204:205], v20 offset:0
    ds_read_b64_tr_b16 v[206:207], v20 offset:4096
    v_mfma_f32_16x16x32_bf16 v[84:87], v[188:191], v[36:39], 0
    ds_read_b64_tr_b16 v[208:209], v21 offset:0
    ds_read_b64_tr_b16 v[210:211], v21 offset:4096
    s_waitcnt lgkmcnt(8)
    v_mfma_f32_16x16x32_bf16 v[88:91], v[192:195], v[32:35], 0
    ds_read_b64_tr_b16 v[212:213], v22 offset:0
    ds_read_b64_tr_b16 v[214:215], v22 offset:4096
    v_mfma_f32_16x16x32_bf16 v[92:95], v[192:195], v[36:39], 0
    ds_read_b64_tr_b16 v[216:217], v23 offset:0
    ds_read_b64_tr_b16 v[218:219], v23 offset:4096
    s_waitcnt lgkmcnt(10)
    v_mfma_f32_16x16x32_bf16 v[96:99], v[196:199], v[32:35], 0
    v_mfma_f32_16x16x32_bf16 v[100:103], v[196:199], v[36:39], 0
    s_waitcnt lgkmcnt(8)
    v_mfma_f32_16x16x32_bf16 v[104:107], v[200:203], v[32:35], 0
    v_mfma_f32_16x16x32_bf16 v[108:111], v[200:203], v[36:39], 0
    v_mfma_f32_16x16x32_bf16 v[144:147], v[28:31], v[32:35], 0
    s_cmp_eq_u32 s45, 0
    s_cbranch_scc0 .L49
    v_mfma_f32_16x16x32_bf16 v[152:155], v[188:191], v[240:243], 0
    v_mfma_f32_16x16x32_bf16 v[156:159], v[192:195], v[240:243], 0
    v_mfma_f32_16x16x32_bf16 v[160:163], v[196:199], v[240:243], 0
    v_mfma_f32_16x16x32_bf16 v[164:167], v[200:203], v[240:243], 0
    v_mfma_f32_16x16x32_bf16 v[184:187], v[28:31], v[240:243], 0
.L49:
    s_waitcnt lgkmcnt(6)
    v_mfma_f32_16x16x32_bf16 v[112:115], v[204:207], v[32:35], 0
    ds_read_b64_tr_b16 v[188:189], v16 offset:8192
    ds_read_b64_tr_b16 v[190:191], v16 offset:12288
    v_mfma_f32_16x16x32_bf16 v[116:119], v[204:207], v[36:39], 0
    ds_read_b64_tr_b16 v[192:193], v17 offset:8192
    ds_read_b64_tr_b16 v[194:195], v17 offset:12288
    s_waitcnt lgkmcnt(8)
    v_mfma_f32_16x16x32_bf16 v[120:123], v[208:211], v[32:35], 0
    ds_read_b64_tr_b16 v[196:197], v18 offset:8192
    ds_read_b64_tr_b16 v[198:199], v18 offset:12288
    v_mfma_f32_16x16x32_bf16 v[124:127], v[208:211], v[36:39], 0
    ds_read_b64_tr_b16 v[200:201], v19 offset:8192
    ds_read_b64_tr_b16 v[202:203], v19 offset:12288
    s_waitcnt lgkmcnt(10)
    v_mfma_f32_16x16x32_bf16 v[128:131], v[212:215], v[32:35], 0
    v_mfma_f32_16x16x32_bf16 v[132:135], v[212:215], v[36:39], 0
    s_waitcnt lgkmcnt(8)
    v_mfma_f32_16x16x32_bf16 v[136:139], v[216:219], v[32:35], 0
    v_mfma_f32_16x16x32_bf16 v[140:143], v[216:219], v[36:39], 0
    v_mfma_f32_16x16x32_bf16 v[148:151], v[28:31], v[36:39], 0
    s_cmp_eq_u32 s45, 0
    s_cbranch_scc0 .L50
    v_mfma_f32_16x16x32_bf16 v[168:171], v[204:207], v[240:243], 0
    v_mfma_f32_16x16x32_bf16 v[172:175], v[208:211], v[240:243], 0
    v_mfma_f32_16x16x32_bf16 v[176:179], v[212:215], v[240:243], 0
    v_mfma_f32_16x16x32_bf16 v[180:183], v[216:219], v[240:243], 0
.L50:
    s_waitcnt lgkmcnt(6)
    v_mfma_f32_16x16x32_bf16 v[80:83], v[188:191], v[40:43], v[80:83]
    ds_read_b64_tr_b16 v[204:205], v20 offset:8192
    ds_read_b64_tr_b16 v[206:207], v20 offset:12288
    v_mfma_f32_16x16x32_bf16 v[84:87], v[188:191], v[44:47], v[84:87]
    ds_read_b64_tr_b16 v[208:209], v21 offset:8192
    ds_read_b64_tr_b16 v[210:211], v21 offset:12288
    s_waitcnt lgkmcnt(8)
    v_mfma_f32_16x16x32_bf16 v[88:91], v[192:195], v[40:43], v[88:91]
    ds_read_b64_tr_b16 v[212:213], v22 offset:8192
    ds_read_b64_tr_b16 v[214:215], v22 offset:12288
    v_mfma_f32_16x16x32_bf16 v[92:95], v[192:195], v[44:47], v[92:95]
    ds_read_b64_tr_b16 v[216:217], v23 offset:8192
    ds_read_b64_tr_b16 v[218:219], v23 offset:12288
    s_waitcnt lgkmcnt(10)
    v_mfma_f32_16x16x32_bf16 v[96:99], v[196:199], v[40:43], v[96:99]
    v_mfma_f32_16x16x32_bf16 v[100:103], v[196:199], v[44:47], v[100:103]
    s_waitcnt lgkmcnt(8)
    v_mfma_f32_16x16x32_bf16 v[104:107], v[200:203], v[40:43], v[104:107]
    v_mfma_f32_16x16x32_bf16 v[108:111], v[200:203], v[44:47], v[108:111]
    v_mfma_f32_16x16x32_bf16 v[144:147], v[28:31], v[40:43], v[144:147]
    s_cmp_eq_u32 s45, 0
    s_cbranch_scc0 .L51
    v_mfma_f32_16x16x32_bf16 v[152:155], v[188:191], v[244:247], v[152:155]
    v_mfma_f32_16x16x32_bf16 v[156:159], v[192:195], v[244:247], v[156:159]
    v_mfma_f32_16x16x32_bf16 v[160:163], v[196:199], v[244:247], v[160:163]
    v_mfma_f32_16x16x32_bf16 v[164:167], v[200:203], v[244:247], v[164:167]
    v_mfma_f32_16x16x32_bf16 v[184:187], v[28:31], v[244:247], v[184:187]
.L51:
    s_waitcnt lgkmcnt(0)
    s_waitcnt vmcnt(8)
    s_barrier
    v_add_u32 v16, 65536, v8
    v_add_u32 v17, 65536, v9
    v_add_u32 v18, 65536, v10
    v_add_u32 v19, 65536, v11
    v_add_u32 v20, 65536, v12
    v_add_u32 v21, 65536, v13
    v_add_u32 v22, 65536, v14
    v_add_u32 v23, 65536, v15
    v_mfma_f32_16x16x32_bf16 v[112:115], v[204:207], v[40:43], v[112:115]
    ds_read_b64_tr_b16 v[188:189], v16 offset:0
    ds_read_b64_tr_b16 v[190:191], v16 offset:4096
    v_mfma_f32_16x16x32_bf16 v[116:119], v[204:207], v[44:47], v[116:119]
    ds_read_b64_tr_b16 v[192:193], v17 offset:0
    ds_read_b64_tr_b16 v[194:195], v17 offset:4096
    v_mfma_f32_16x16x32_bf16 v[120:123], v[208:211], v[40:43], v[120:123]
    ds_read_b64_tr_b16 v[196:197], v18 offset:0
    ds_read_b64_tr_b16 v[198:199], v18 offset:4096
    v_mfma_f32_16x16x32_bf16 v[124:127], v[208:211], v[44:47], v[124:127]
    ds_read_b64_tr_b16 v[200:201], v19 offset:0
    ds_read_b64_tr_b16 v[202:203], v19 offset:4096
    v_mfma_f32_16x16x32_bf16 v[128:131], v[212:215], v[40:43], v[128:131]
    v_mfma_f32_16x16x32_bf16 v[132:135], v[212:215], v[44:47], v[132:135]
    v_mfma_f32_16x16x32_bf16 v[136:139], v[216:219], v[40:43], v[136:139]
    v_mfma_f32_16x16x32_bf16 v[140:143], v[216:219], v[44:47], v[140:143]
    v_mfma_f32_16x16x32_bf16 v[148:151], v[28:31], v[44:47], v[148:151]
    s_cmp_eq_u32 s45, 0
    s_cbranch_scc0 .L52
    v_mfma_f32_16x16x32_bf16 v[168:171], v[204:207], v[244:247], v[168:171]
    v_mfma_f32_16x16x32_bf16 v[172:175], v[208:211], v[244:247], v[172:175]
    v_mfma_f32_16x16x32_bf16 v[176:179], v[212:215], v[244:247], v[176:179]
    v_mfma_f32_16x16x32_bf16 v[180:183], v[216:219], v[244:247], v[180:183]
.L52:
    s_waitcnt lgkmcnt(6)
    v_mfma_f32_16x16x32_bf16 v[80:83], v[188:191], v[48:51], v[80:83]
    ds_read_b64_tr_b16 v[204:205], v20 offset:0
    ds_read_b64_tr_b16 v[206:207], v20 offset:4096
    v_mfma_f32_16x16x32_bf16 v[84:87], v[188:191], v[52:55], v[84:87]
    ds_read_b64_tr_b16 v[208:209], v21 offset:0
    ds_read_b64_tr_b16 v[210:211], v21 offset:4096
    s_waitcnt lgkmcnt(8)
    v_mfma_f32_16x16x32_bf16 v[88:91], v[192:195], v[48:51], v[88:91]
    ds_read_b64_tr_b16 v[212:213], v22 offset:0
    ds_read_b64_tr_b16 v[214:215], v22 offset:4096
    v_mfma_f32_16x16x32_bf16 v[92:95], v[192:195], v[52:55], v[92:95]
    ds_read_b64_tr_b16 v[216:217], v23 offset:0
    ds_read_b64_tr_b16 v[218:219], v23 offset:4096
    s_waitcnt lgkmcnt(10)
    v_mfma_f32_16x16x32_bf16 v[96:99], v[196:199], v[48:51], v[96:99]
    v_mfma_f32_16x16x32_bf16 v[100:103], v[196:199], v[52:55], v[100:103]
    s_waitcnt lgkmcnt(8)
    v_mfma_f32_16x16x32_bf16 v[104:107], v[200:203], v[48:51], v[104:107]
    v_mfma_f32_16x16x32_bf16 v[108:111], v[200:203], v[52:55], v[108:111]
    v_mfma_f32_16x16x32_bf16 v[144:147], v[28:31], v[48:51], v[144:147]
    s_cmp_eq_u32 s45, 1
    s_cbranch_scc0 .L53
    v_mfma_f32_16x16x32_bf16 v[152:155], v[188:191], v[240:243], 0
    v_mfma_f32_16x16x32_bf16 v[156:159], v[192:195], v[240:243], 0
    v_mfma_f32_16x16x32_bf16 v[160:163], v[196:199], v[240:243], 0
    v_mfma_f32_16x16x32_bf16 v[164:167], v[200:203], v[240:243], 0
    v_mfma_f32_16x16x32_bf16 v[184:187], v[28:31], v[240:243], 0
.L53:
    s_waitcnt lgkmcnt(6)
    v_mfma_f32_16x16x32_bf16 v[112:115], v[204:207], v[48:51], v[112:115]
    ds_read_b64_tr_b16 v[188:189], v16 offset:8192
    ds_read_b64_tr_b16 v[190:191], v16 offset:12288
    v_mfma_f32_16x16x32_bf16 v[116:119], v[204:207], v[52:55], v[116:119]
    ds_read_b64_tr_b16 v[192:193], v17 offset:8192
    ds_read_b64_tr_b16 v[194:195], v17 offset:12288
    s_waitcnt lgkmcnt(8)
    v_mfma_f32_16x16x32_bf16 v[120:123], v[208:211], v[48:51], v[120:123]
    ds_read_b64_tr_b16 v[196:197], v18 offset:8192
    ds_read_b64_tr_b16 v[198:199], v18 offset:12288
    v_mfma_f32_16x16x32_bf16 v[124:127], v[208:211], v[52:55], v[124:127]
    ds_read_b64_tr_b16 v[200:201], v19 offset:8192
    ds_read_b64_tr_b16 v[202:203], v19 offset:12288
    s_waitcnt lgkmcnt(10)
    v_mfma_f32_16x16x32_bf16 v[128:131], v[212:215], v[48:51], v[128:131]
    v_mfma_f32_16x16x32_bf16 v[132:135], v[212:215], v[52:55], v[132:135]
    s_waitcnt lgkmcnt(8)
    v_mfma_f32_16x16x32_bf16 v[136:139], v[216:219], v[48:51], v[136:139]
    v_mfma_f32_16x16x32_bf16 v[140:143], v[216:219], v[52:55], v[140:143]
    v_mfma_f32_16x16x32_bf16 v[148:151], v[28:31], v[52:55], v[148:151]
    s_cmp_eq_u32 s45, 1
    s_cbranch_scc0 .L54
    v_mfma_f32_16x16x32_bf16 v[168:171], v[204:207], v[240:243], 0
    v_mfma_f32_16x16x32_bf16 v[172:175], v[208:211], v[240:243], 0
    v_mfma_f32_16x16x32_bf16 v[176:179], v[212:215], v[240:243], 0
    v_mfma_f32_16x16x32_bf16 v[180:183], v[216:219], v[240:243], 0
.L54:
    s_waitcnt lgkmcnt(6)
    v_mfma_f32_16x16x32_bf16 v[80:83], v[188:191], v[56:59], v[80:83]
    ds_read_b64_tr_b16 v[204:205], v20 offset:8192
    ds_read_b64_tr_b16 v[206:207], v20 offset:12288
    v_mfma_f32_16x16x32_bf16 v[84:87], v[188:191], v[60:63], v[84:87]
    ds_read_b64_tr_b16 v[208:209], v21 offset:8192
    ds_read_b64_tr_b16 v[210:211], v21 offset:12288
    s_waitcnt lgkmcnt(8)
    v_mfma_f32_16x16x32_bf16 v[88:91], v[192:195], v[56:59], v[88:91]
    ds_read_b64_tr_b16 v[212:213], v22 offset:8192
    ds_read_b64_tr_b16 v[214:215], v22 offset:12288
    v_mfma_f32_16x16x32_bf16 v[92:95], v[192:195], v[60:63], v[92:95]
    ds_read_b64_tr_b16 v[216:217], v23 offset:8192
    ds_read_b64_tr_b16 v[218:219], v23 offset:12288
    s_waitcnt lgkmcnt(10)
    v_mfma_f32_16x16x32_bf16 v[96:99], v[196:199], v[56:59], v[96:99]
    v_mfma_f32_16x16x32_bf16 v[100:103], v[196:199], v[60:63], v[100:103]
    s_waitcnt lgkmcnt(8)
    v_mfma_f32_16x16x32_bf16 v[104:107], v[200:203], v[56:59], v[104:107]
    v_mfma_f32_16x16x32_bf16 v[108:111], v[200:203], v[60:63], v[108:111]
    v_mfma_f32_16x16x32_bf16 v[144:147], v[28:31], v[56:59], v[144:147]
    s_cmp_eq_u32 s45, 1
    s_cbranch_scc0 .L55
    v_mfma_f32_16x16x32_bf16 v[152:155], v[188:191], v[244:247], v[152:155]
    v_mfma_f32_16x16x32_bf16 v[156:159], v[192:195], v[244:247], v[156:159]
    v_mfma_f32_16x16x32_bf16 v[160:163], v[196:199], v[244:247], v[160:163]
    v_mfma_f32_16x16x32_bf16 v[164:167], v[200:203], v[244:247], v[164:167]
    v_mfma_f32_16x16x32_bf16 v[184:187], v[28:31], v[244:247], v[184:187]
.L55:
    s_waitcnt lgkmcnt(0)
    s_waitcnt vmcnt(4)
    s_barrier
    v_add_u32 v16, 118784, v8
    v_add_u32 v17, 118784, v9
    v_add_u32 v18, 118784, v10
    v_add_u32 v19, 118784, v11
    v_add_u32 v20, 118784, v12
    v_add_u32 v21, 118784, v13
    v_add_u32 v22, 118784, v14
    v_add_u32 v23, 118784, v15
    v_mfma_f32_16x16x32_bf16 v[112:115], v[204:207], v[56:59], v[112:115]
    ds_read_b64_tr_b16 v[188:189], v16 offset:0
    ds_read_b64_tr_b16 v[190:191], v16 offset:4096
    v_mfma_f32_16x16x32_bf16 v[116:119], v[204:207], v[60:63], v[116:119]
    ds_read_b64_tr_b16 v[192:193], v17 offset:0
    ds_read_b64_tr_b16 v[194:195], v17 offset:4096
    v_mfma_f32_16x16x32_bf16 v[120:123], v[208:211], v[56:59], v[120:123]
    ds_read_b64_tr_b16 v[196:197], v18 offset:0
    ds_read_b64_tr_b16 v[198:199], v18 offset:4096
    v_mfma_f32_16x16x32_bf16 v[124:127], v[208:211], v[60:63], v[124:127]
    ds_read_b64_tr_b16 v[200:201], v19 offset:0
    ds_read_b64_tr_b16 v[202:203], v19 offset:4096
    v_mfma_f32_16x16x32_bf16 v[128:131], v[212:215], v[56:59], v[128:131]
    v_mfma_f32_16x16x32_bf16 v[132:135], v[212:215], v[60:63], v[132:135]
    v_mfma_f32_16x16x32_bf16 v[136:139], v[216:219], v[56:59], v[136:139]
    v_mfma_f32_16x16x32_bf16 v[140:143], v[216:219], v[60:63], v[140:143]
    v_mfma_f32_16x16x32_bf16 v[148:151], v[28:31], v[60:63], v[148:151]
    s_cmp_eq_u32 s45, 1
    s_cbranch_scc0 .L56
    v_mfma_f32_16x16x32_bf16 v[168:171], v[204:207], v[244:247], v[168:171]
    v_mfma_f32_16x16x32_bf16 v[172:175], v[208:211], v[244:247], v[172:175]
    v_mfma_f32_16x16x32_bf16 v[176:179], v[212:215], v[244:247], v[176:179]
    v_mfma_f32_16x16x32_bf16 v[180:183], v[216:219], v[244:247], v[180:183]
.L56:
    s_waitcnt lgkmcnt(6)
    v_mfma_f32_16x16x32_bf16 v[80:83], v[188:191], v[64:67], v[80:83]
    ds_read_b64_tr_b16 v[204:205], v20 offset:0
    ds_read_b64_tr_b16 v[206:207], v20 offset:4096
    v_mfma_f32_16x16x32_bf16 v[84:87], v[188:191], v[68:71], v[84:87]
    ds_read_b64_tr_b16 v[208:209], v21 offset:0
    ds_read_b64_tr_b16 v[210:211], v21 offset:4096
    s_waitcnt lgkmcnt(8)
    v_mfma_f32_16x16x32_bf16 v[88:91], v[192:195], v[64:67], v[88:91]
    ds_read_b64_tr_b16 v[212:213], v22 offset:0
    ds_read_b64_tr_b16 v[214:215], v22 offset:4096
    v_mfma_f32_16x16x32_bf16 v[92:95], v[192:195], v[68:71], v[92:95]
    ds_read_b64_tr_b16 v[216:217], v23 offset:0
    ds_read_b64_tr_b16 v[218:219], v23 offset:4096
    s_waitcnt lgkmcnt(10)
    v_mfma_f32_16x16x32_bf16 v[96:99], v[196:199], v[64:67], v[96:99]
    v_mfma_f32_16x16x32_bf16 v[100:103], v[196:199], v[68:71], v[100:103]
    s_waitcnt lgkmcnt(8)
    v_mfma_f32_16x16x32_bf16 v[104:107], v[200:203], v[64:67], v[104:107]
    v_mfma_f32_16x16x32_bf16 v[108:111], v[200:203], v[68:71], v[108:111]
    v_mfma_f32_16x16x32_bf16 v[144:147], v[28:31], v[64:67], v[144:147]
    s_cmp_eq_u32 s45, 2
    s_cbranch_scc0 .L57
    v_mfma_f32_16x16x32_bf16 v[152:155], v[188:191], v[240:243], 0
    v_mfma_f32_16x16x32_bf16 v[156:159], v[192:195], v[240:243], 0
    v_mfma_f32_16x16x32_bf16 v[160:163], v[196:199], v[240:243], 0
    v_mfma_f32_16x16x32_bf16 v[164:167], v[200:203], v[240:243], 0
    v_mfma_f32_16x16x32_bf16 v[184:187], v[28:31], v[240:243], 0
.L57:
    s_waitcnt lgkmcnt(6)
    v_mfma_f32_16x16x32_bf16 v[112:115], v[204:207], v[64:67], v[112:115]
    ds_read_b64_tr_b16 v[188:189], v16 offset:8192
    ds_read_b64_tr_b16 v[190:191], v16 offset:12288
    v_mfma_f32_16x16x32_bf16 v[116:119], v[204:207], v[68:71], v[116:119]
    ds_read_b64_tr_b16 v[192:193], v17 offset:8192
    ds_read_b64_tr_b16 v[194:195], v17 offset:12288
    s_waitcnt lgkmcnt(8)
    v_mfma_f32_16x16x32_bf16 v[120:123], v[208:211], v[64:67], v[120:123]
    ds_read_b64_tr_b16 v[196:197], v18 offset:8192
    ds_read_b64_tr_b16 v[198:199], v18 offset:12288
    v_mfma_f32_16x16x32_bf16 v[124:127], v[208:211], v[68:71], v[124:127]
    ds_read_b64_tr_b16 v[200:201], v19 offset:8192
    ds_read_b64_tr_b16 v[202:203], v19 offset:12288
    s_waitcnt lgkmcnt(10)
    v_mfma_f32_16x16x32_bf16 v[128:131], v[212:215], v[64:67], v[128:131]
    v_mfma_f32_16x16x32_bf16 v[132:135], v[212:215], v[68:71], v[132:135]
    s_waitcnt lgkmcnt(8)
    v_mfma_f32_16x16x32_bf16 v[136:139], v[216:219], v[64:67], v[136:139]
    v_mfma_f32_16x16x32_bf16 v[140:143], v[216:219], v[68:71], v[140:143]
    v_mfma_f32_16x16x32_bf16 v[148:151], v[28:31], v[68:71], v[148:151]
    s_cmp_eq_u32 s45, 2
    s_cbranch_scc0 .L58
    v_mfma_f32_16x16x32_bf16 v[168:171], v[204:207], v[240:243], 0
    v_mfma_f32_16x16x32_bf16 v[172:175], v[208:211], v[240:243], 0
    v_mfma_f32_16x16x32_bf16 v[176:179], v[212:215], v[240:243], 0
    v_mfma_f32_16x16x32_bf16 v[180:183], v[216:219], v[240:243], 0
.L58:
    s_waitcnt lgkmcnt(6)
    v_mfma_f32_16x16x32_bf16 v[80:83], v[188:191], v[72:75], v[80:83]
    ds_read_b64_tr_b16 v[204:205], v20 offset:8192
    ds_read_b64_tr_b16 v[206:207], v20 offset:12288
    v_mfma_f32_16x16x32_bf16 v[84:87], v[188:191], v[76:79], v[84:87]
    ds_read_b64_tr_b16 v[208:209], v21 offset:8192
    ds_read_b64_tr_b16 v[210:211], v21 offset:12288
    s_waitcnt lgkmcnt(8)
    v_mfma_f32_16x16x32_bf16 v[88:91], v[192:195], v[72:75], v[88:91]
    ds_read_b64_tr_b16 v[212:213], v22 offset:8192
    ds_read_b64_tr_b16 v[214:215], v22 offset:12288
    v_mfma_f32_16x16x32_bf16 v[92:95], v[192:195], v[76:79], v[92:95]
    ds_read_b64_tr_b16 v[216:217], v23 offset:8192
    ds_read_b64_tr_b16 v[218:219], v23 offset:12288
    s_waitcnt lgkmcnt(10)
    v_mfma_f32_16x16x32_bf16 v[96:99], v[196:199], v[72:75], v[96:99]
    v_mfma_f32_16x16x32_bf16 v[100:103], v[196:199], v[76:79], v[100:103]
    s_waitcnt lgkmcnt(8)
    v_mfma_f32_16x16x32_bf16 v[104:107], v[200:203], v[72:75], v[104:107]
    v_mfma_f32_16x16x32_bf16 v[108:111], v[200:203], v[76:79], v[108:111]
    v_mfma_f32_16x16x32_bf16 v[144:147], v[28:31], v[72:75], v[144:147]
    s_cmp_eq_u32 s45, 2
    s_cbranch_scc0 .L59
    v_mfma_f32_16x16x32_bf16 v[152:155], v[188:191], v[244:247], v[152:155]
    v_mfma_f32_16x16x32_bf16 v[156:159], v[192:195], v[244:247], v[156:159]
    v_mfma_f32_16x16x32_bf16 v[160:163], v[196:199], v[244:247], v[160:163]
    v_mfma_f32_16x16x32_bf16 v[164:167], v[200:203], v[244:247], v[164:167]
    v_mfma_f32_16x16x32_bf16 v[184:187], v[28:31], v[244:247], v[184:187]
.L59:
    s_waitcnt lgkmcnt(0)
    s_waitcnt vmcnt(0)
    s_barrier
    v_add_u32 v16, 135168, v8
    v_add_u32 v17, 135168, v9
    v_add_u32 v18, 135168, v10
    v_add_u32 v19, 135168, v11
    v_add_u32 v20, 135168, v12
    v_add_u32 v21, 135168, v13
    v_add_u32 v22, 135168, v14
    v_add_u32 v23, 135168, v15
    v_mfma_f32_16x16x32_bf16 v[112:115], v[204:207], v[72:75], v[112:115]
    ds_read_b64_tr_b16 v[188:189], v16 offset:0
    ds_read_b64_tr_b16 v[190:191], v16 offset:4096
    v_mfma_f32_16x16x32_bf16 v[116:119], v[204:207], v[76:79], v[116:119]
    ds_read_b64_tr_b16 v[192:193], v17 offset:0
    ds_read_b64_tr_b16 v[194:195], v17 offset:4096
    v_mfma_f32_16x16x32_bf16 v[120:123], v[208:211], v[72:75], v[120:123]
    ds_read_b64_tr_b16 v[196:197], v18 offset:0
    ds_read_b64_tr_b16 v[198:199], v18 offset:4096
    v_mfma_f32_16x16x32_bf16 v[124:127], v[208:211], v[76:79], v[124:127]
    ds_read_b64_tr_b16 v[200:201], v19 offset:0
    ds_read_b64_tr_b16 v[202:203], v19 offset:4096
    v_mfma_f32_16x16x32_bf16 v[128:131], v[212:215], v[72:75], v[128:131]
    v_mfma_f32_16x16x32_bf16 v[132:135], v[212:215], v[76:79], v[132:135]
    v_mfma_f32_16x16x32_bf16 v[136:139], v[216:219], v[72:75], v[136:139]
    v_mfma_f32_16x16x32_bf16 v[140:143], v[216:219], v[76:79], v[140:143]
    v_mfma_f32_16x16x32_bf16 v[148:151], v[28:31], v[76:79], v[148:151]
    s_cmp_eq_u32 s45, 2
    s_cbranch_scc0 .L60
    v_mfma_f32_16x16x32_bf16 v[168:171], v[204:207], v[244:247], v[168:171]
    v_mfma_f32_16x16x32_bf16 v[172:175], v[208:211], v[244:247], v[172:175]
    v_mfma_f32_16x16x32_bf16 v[176:179], v[212:215], v[244:247], v[176:179]
    v_mfma_f32_16x16x32_bf16 v[180:183], v[216:219], v[244:247], v[180:183]
.L60:
    s_waitcnt lgkmcnt(6)
    v_mfma_f32_16x16x32_bf16 v[80:83], v[188:191], v[224:227], v[80:83]
    ds_read_b64_tr_b16 v[204:205], v20 offset:0
    ds_read_b64_tr_b16 v[206:207], v20 offset:4096
    v_mfma_f32_16x16x32_bf16 v[84:87], v[188:191], v[228:231], v[84:87]
    ds_read_b64_tr_b16 v[208:209], v21 offset:0
    ds_read_b64_tr_b16 v[210:211], v21 offset:4096
    s_waitcnt lgkmcnt(8)
    v_mfma_f32_16x16x32_bf16 v[88:91], v[192:195], v[224:227], v[88:91]
    ds_read_b64_tr_b16 v[212:213], v22 offset:0
    ds_read_b64_tr_b16 v[214:215], v22 offset:4096
    v_mfma_f32_16x16x32_bf16 v[92:95], v[192:195], v[228:231], v[92:95]
    ds_read_b64_tr_b16 v[216:217], v23 offset:0
    ds_read_b64_tr_b16 v[218:219], v23 offset:4096
    s_waitcnt lgkmcnt(10)
    v_mfma_f32_16x16x32_bf16 v[96:99], v[196:199], v[224:227], v[96:99]
    v_mfma_f32_16x16x32_bf16 v[100:103], v[196:199], v[228:231], v[100:103]
    s_waitcnt lgkmcnt(8)
    v_mfma_f32_16x16x32_bf16 v[104:107], v[200:203], v[224:227], v[104:107]
    v_mfma_f32_16x16x32_bf16 v[108:111], v[200:203], v[228:231], v[108:111]
    v_mfma_f32_16x16x32_bf16 v[144:147], v[28:31], v[224:227], v[144:147]
    s_cmp_eq_u32 s45, 3
    s_cbranch_scc0 .L61
    v_mfma_f32_16x16x32_bf16 v[152:155], v[188:191], v[240:243], 0
    v_mfma_f32_16x16x32_bf16 v[156:159], v[192:195], v[240:243], 0
    v_mfma_f32_16x16x32_bf16 v[160:163], v[196:199], v[240:243], 0
    v_mfma_f32_16x16x32_bf16 v[164:167], v[200:203], v[240:243], 0
    v_mfma_f32_16x16x32_bf16 v[184:187], v[28:31], v[240:243], 0
.L61:
    s_waitcnt lgkmcnt(6)
    v_mfma_f32_16x16x32_bf16 v[112:115], v[204:207], v[224:227], v[112:115]
    ds_read_b64_tr_b16 v[188:189], v16 offset:8192
    ds_read_b64_tr_b16 v[190:191], v16 offset:12288
    v_mfma_f32_16x16x32_bf16 v[116:119], v[204:207], v[228:231], v[116:119]
    ds_read_b64_tr_b16 v[192:193], v17 offset:8192
    ds_read_b64_tr_b16 v[194:195], v17 offset:12288
    s_waitcnt lgkmcnt(8)
    v_mfma_f32_16x16x32_bf16 v[120:123], v[208:211], v[224:227], v[120:123]
    ds_read_b64_tr_b16 v[196:197], v18 offset:8192
    ds_read_b64_tr_b16 v[198:199], v18 offset:12288
    v_mfma_f32_16x16x32_bf16 v[124:127], v[208:211], v[228:231], v[124:127]
    ds_read_b64_tr_b16 v[200:201], v19 offset:8192
    ds_read_b64_tr_b16 v[202:203], v19 offset:12288
    s_waitcnt lgkmcnt(10)
    v_mfma_f32_16x16x32_bf16 v[128:131], v[212:215], v[224:227], v[128:131]
    v_mfma_f32_16x16x32_bf16 v[132:135], v[212:215], v[228:231], v[132:135]
    s_waitcnt lgkmcnt(8)
    v_mfma_f32_16x16x32_bf16 v[136:139], v[216:219], v[224:227], v[136:139]
    v_mfma_f32_16x16x32_bf16 v[140:143], v[216:219], v[228:231], v[140:143]
    v_mfma_f32_16x16x32_bf16 v[148:151], v[28:31], v[228:231], v[148:151]
    s_cmp_eq_u32 s45, 3
    s_cbranch_scc0 .L62
    v_mfma_f32_16x16x32_bf16 v[168:171], v[204:207], v[240:243], 0
    v_mfma_f32_16x16x32_bf16 v[172:175], v[208:211], v[240:243], 0
    v_mfma_f32_16x16x32_bf16 v[176:179], v[212:215], v[240:243], 0
    v_mfma_f32_16x16x32_bf16 v[180:183], v[216:219], v[240:243], 0
.L62:
    s_waitcnt lgkmcnt(6)
    v_mfma_f32_16x16x32_bf16 v[80:83], v[188:191], v[232:235], v[80:83]
    ds_read_b64_tr_b16 v[204:205], v20 offset:8192
    ds_read_b64_tr_b16 v[206:207], v20 offset:12288
    v_mfma_f32_16x16x32_bf16 v[84:87], v[188:191], v[236:239], v[84:87]
    ds_read_b64_tr_b16 v[208:209], v21 offset:8192
    ds_read_b64_tr_b16 v[210:211], v21 offset:12288
    s_waitcnt lgkmcnt(8)
    v_mfma_f32_16x16x32_bf16 v[88:91], v[192:195], v[232:235], v[88:91]
    ds_read_b64_tr_b16 v[212:213], v22 offset:8192
    ds_read_b64_tr_b16 v[214:215], v22 offset:12288
    v_mfma_f32_16x16x32_bf16 v[92:95], v[192:195], v[236:239], v[92:95]
    ds_read_b64_tr_b16 v[216:217], v23 offset:8192
    ds_read_b64_tr_b16 v[218:219], v23 offset:12288
    s_waitcnt lgkmcnt(10)
    v_mfma_f32_16x16x32_bf16 v[96:99], v[196:199], v[232:235], v[96:99]
    v_mfma_f32_16x16x32_bf16 v[100:103], v[196:199], v[236:239], v[100:103]
    s_waitcnt lgkmcnt(8)
    v_mfma_f32_16x16x32_bf16 v[104:107], v[200:203], v[232:235], v[104:107]
    v_mfma_f32_16x16x32_bf16 v[108:111], v[200:203], v[236:239], v[108:111]
    v_mfma_f32_16x16x32_bf16 v[144:147], v[28:31], v[232:235], v[144:147]
    s_cmp_eq_u32 s45, 3
    s_cbranch_scc0 .L63
    v_mfma_f32_16x16x32_bf16 v[152:155], v[188:191], v[244:247], v[152:155]
    v_mfma_f32_16x16x32_bf16 v[156:159], v[192:195], v[244:247], v[156:159]
    v_mfma_f32_16x16x32_bf16 v[160:163], v[196:199], v[244:247], v[160:163]
    v_mfma_f32_16x16x32_bf16 v[164:167], v[200:203], v[244:247], v[164:167]
    v_mfma_f32_16x16x32_bf16 v[184:187], v[28:31], v[244:247], v[184:187]
.L63:
    s_waitcnt lgkmcnt(6)
    v_mfma_f32_16x16x32_bf16 v[112:115], v[204:207], v[232:235], v[112:115]
    v_mfma_f32_16x16x32_bf16 v[116:119], v[204:207], v[236:239], v[116:119]
    s_waitcnt lgkmcnt(4)
    v_mfma_f32_16x16x32_bf16 v[120:123], v[208:211], v[232:235], v[120:123]
    v_mfma_f32_16x16x32_bf16 v[124:127], v[208:211], v[236:239], v[124:127]
    s_waitcnt lgkmcnt(2)
    v_mfma_f32_16x16x32_bf16 v[128:131], v[212:215], v[232:235], v[128:131]
    v_mfma_f32_16x16x32_bf16 v[132:135], v[212:215], v[236:239], v[132:135]
    s_waitcnt lgkmcnt(0)
    v_mfma_f32_16x16x32_bf16 v[136:139], v[216:219], v[232:235], v[136:139]
    v_mfma_f32_16x16x32_bf16 v[140:143], v[216:219], v[236:239], v[140:143]
    v_mfma_f32_16x16x32_bf16 v[148:151], v[28:31], v[236:239], v[148:151]
    s_cmp_eq_u32 s45, 3
    s_cbranch_scc0 .L64
    v_mfma_f32_16x16x32_bf16 v[168:171], v[204:207], v[244:247], v[168:171]
    v_mfma_f32_16x16x32_bf16 v[172:175], v[208:211], v[244:247], v[172:175]
    v_mfma_f32_16x16x32_bf16 v[176:179], v[212:215], v[244:247], v[176:179]
    v_mfma_f32_16x16x32_bf16 v[180:183], v[216:219], v[244:247], v[180:183]
.L64:
    s_waitcnt lgkmcnt(0)
    s_barrier
    s_mul_i32 s47, s45, 9216
    s_add_u32 s47, s47, 118784
    v_add_u32 v1, s47, v26
    v_lshlrev_b32 v2, 2, v0
    v_add_u32 v2, s47, v2
    s_mul_i32 s47, s45, 8704
    s_add_u32 s47, s47, 49152
    v_add_u32 v3, s47, v26
    v_lshlrev_b32 v4, 2, v0
    v_add_u32 v4, s47, v4
    ds_write_b128 v1, v[80:83] offset:0
    ds_write_b128 v1, v[88:91] offset:1024
    ds_write_b128 v1, v[96:99] offset:2048
    ds_write_b128 v1, v[104:107] offset:3072
    ds_write_b128 v1, v[112:115] offset:4096
    ds_write_b128 v1, v[120:123] offset:5120
    ds_write_b128 v1, v[128:131] offset:6144
    ds_write_b128 v1, v[136:139] offset:7168
    ds_write_b32 v2, v144 offset:8192
    ds_write_b32 v2, v248 offset:8448
    s_waitcnt lgkmcnt(4)
    ds_write_b128 v3, v[152:155] offset:0
    ds_write_b128 v3, v[156:159] offset:1024
    ds_write_b128 v3, v[160:163] offset:2048
    ds_write_b128 v3, v[164:167] offset:3072
    ds_write_b128 v3, v[168:171] offset:4096
    ds_write_b128 v3, v[172:175] offset:5120
    ds_write_b128 v3, v[176:179] offset:6144
    ds_write_b128 v3, v[180:183] offset:7168
    ds_write_b32 v4, v184 offset:8192
    ds_write_b32 v4, v252 offset:8448
    s_waitcnt lgkmcnt(0)
    s_mul_i32 s48, s45, 9216
    s_add_u32 s48, s48, 0
    v_add_u32 v1, s48, v26
    v_lshlrev_b32 v2, 2, v0
    v_add_u32 v2, s48, v2
    ds_read_b32 v8, v2 offset:8192
    ds_read_b32 v10, v2 offset:8448
    ds_read_b128 v[32:35], v1 offset:0
    ds_read_b128 v[36:39], v1 offset:1024
    ds_read_b128 v[40:43], v1 offset:2048
    ds_read_b128 v[44:47], v1 offset:3072
    ds_read_b128 v[48:51], v1 offset:4096
    ds_read_b128 v[52:55], v1 offset:5120
    ds_read_b128 v[56:59], v1 offset:6144
    ds_read_b128 v[60:63], v1 offset:7168
    s_mul_i32 s47, s51, 9
    s_lshl_b32 s57, s52, 2
    s_lshl_b32 s48, s45, 1
    s_add_u32 s48, s48, 1
    s_add_u32 s48, s48, s47
    s_lshl_b32 s48, s48, 7
    s_add_u32 s48, s48, s57
    s_lshl_b32 s48, s48, 10
    s_waitcnt lgkmcnt(8)
    v_min_f32 v12, v10, v250
    v_sub_f32 v10, v12, v10
    v_sub_f32 v13, v12, v250
    v_exp_f32 v10, v10
    v_exp_f32 v13, v13
    s_nop 0
    v_mul_f32 v8, v8, v10
    v_fmac_f32 v8, v13, v148
    v_rcp_f32 v8, v8
    s_nop 0
    v_mul_f32 v10, v10, v8
    v_mul_f32 v8, v13, v8
    s_waitcnt lgkmcnt(6)
    v_mul_f32 v32, v32, v10
    v_mul_f32 v33, v33, v10
    v_mul_f32 v34, v34, v10
    v_mul_f32 v35, v35, v10
    v_fmac_f32 v32, v84, v8
    v_fmac_f32 v33, v85, v8
    v_fmac_f32 v34, v86, v8
    v_fmac_f32 v35, v87, v8
    v_mul_f32 v36, v36, v10
    v_mul_f32 v37, v37, v10
    v_mul_f32 v38, v38, v10
    v_mul_f32 v39, v39, v10
    v_fmac_f32 v36, v92, v8
    v_fmac_f32 v37, v93, v8
    v_fmac_f32 v38, v94, v8
    v_fmac_f32 v39, v95, v8
    v_cvt_pk_bf16_f32 v64, v32, v33
    v_cvt_pk_bf16_f32 v65, v34, v35
    v_cvt_pk_bf16_f32 v66, v36, v37
    v_cvt_pk_bf16_f32 v67, v38, v39
    buffer_store_dwordx4 v[64:67], v26, s[40:43], s48 offen offset:0 sc0 sc1
    s_waitcnt lgkmcnt(4)
    v_mul_f32 v40, v40, v10
    v_mul_f32 v41, v41, v10
    v_mul_f32 v42, v42, v10
    v_mul_f32 v43, v43, v10
    v_fmac_f32 v40, v100, v8
    v_fmac_f32 v41, v101, v8
    v_fmac_f32 v42, v102, v8
    v_fmac_f32 v43, v103, v8
    v_mul_f32 v44, v44, v10
    v_mul_f32 v45, v45, v10
    v_mul_f32 v46, v46, v10
    v_mul_f32 v47, v47, v10
    v_fmac_f32 v44, v108, v8
    v_fmac_f32 v45, v109, v8
    v_fmac_f32 v46, v110, v8
    v_fmac_f32 v47, v111, v8
    v_cvt_pk_bf16_f32 v68, v40, v41
    v_cvt_pk_bf16_f32 v69, v42, v43
    v_cvt_pk_bf16_f32 v70, v44, v45
    v_cvt_pk_bf16_f32 v71, v46, v47
    buffer_store_dwordx4 v[68:71], v26, s[40:43], s48 offen offset:1024 sc0 sc1
    s_waitcnt lgkmcnt(2)
    v_mul_f32 v48, v48, v10
    v_mul_f32 v49, v49, v10
    v_mul_f32 v50, v50, v10
    v_mul_f32 v51, v51, v10
    v_fmac_f32 v48, v116, v8
    v_fmac_f32 v49, v117, v8
    v_fmac_f32 v50, v118, v8
    v_fmac_f32 v51, v119, v8
    v_mul_f32 v52, v52, v10
    v_mul_f32 v53, v53, v10
    v_mul_f32 v54, v54, v10
    v_mul_f32 v55, v55, v10
    v_fmac_f32 v52, v124, v8
    v_fmac_f32 v53, v125, v8
    v_fmac_f32 v54, v126, v8
    v_fmac_f32 v55, v127, v8
    v_cvt_pk_bf16_f32 v72, v48, v49
    v_cvt_pk_bf16_f32 v73, v50, v51
    v_cvt_pk_bf16_f32 v74, v52, v53
    v_cvt_pk_bf16_f32 v75, v54, v55
    buffer_store_dwordx4 v[72:75], v26, s[40:43], s48 offen offset:2048 sc0 sc1
    s_waitcnt lgkmcnt(0)
    v_mul_f32 v56, v56, v10
    v_mul_f32 v57, v57, v10
    v_mul_f32 v58, v58, v10
    v_mul_f32 v59, v59, v10
    v_fmac_f32 v56, v132, v8
    v_fmac_f32 v57, v133, v8
    v_fmac_f32 v58, v134, v8
    v_fmac_f32 v59, v135, v8
    v_mul_f32 v60, v60, v10
    v_mul_f32 v61, v61, v10
    v_mul_f32 v62, v62, v10
    v_mul_f32 v63, v63, v10
    v_fmac_f32 v60, v140, v8
    v_fmac_f32 v61, v141, v8
    v_fmac_f32 v62, v142, v8
    v_fmac_f32 v63, v143, v8
    v_cvt_pk_bf16_f32 v76, v56, v57
    v_cvt_pk_bf16_f32 v77, v58, v59
    v_cvt_pk_bf16_f32 v78, v60, v61
    v_cvt_pk_bf16_f32 v79, v62, v63
    buffer_store_dwordx4 v[76:79], v26, s[40:43], s48 offen offset:3072 sc0 sc1
    s_waitcnt lgkmcnt(0)
    s_barrier
    s_lshl_b32 s48, s45, 11
    v_add_u32 v3, s48, v26
    v_lshlrev_b32 v4, 2, v0
    v_add_u32 v5, 83968, v4
    ds_read_b32 v32, v5 offset:8192
    ds_read_b32 v40, v5 offset:8448
    v_add_u32 v5, 92672, v4
    ds_read_b32 v33, v5 offset:8192
    ds_read_b32 v41, v5 offset:8448
    v_add_u32 v5, 101376, v4
    ds_read_b32 v34, v5 offset:8192
    ds_read_b32 v42, v5 offset:8448
    v_add_u32 v5, 110080, v4
    ds_read_b32 v35, v5 offset:8192
    ds_read_b32 v43, v5 offset:8448
    v_add_u32 v5, 49152, v4
    ds_read_b32 v36, v5 offset:8192
    ds_read_b32 v44, v5 offset:8448
    v_add_u32 v5, 57856, v4
    ds_read_b32 v37, v5 offset:8192
    ds_read_b32 v45, v5 offset:8448
    s_waitcnt lgkmcnt(6)
    v_add_u32 v5, 66560, v4
    ds_read_b32 v38, v5 offset:8192
    ds_read_b32 v46, v5 offset:8448
    v_add_u32 v5, 75264, v4
    ds_read_b32 v39, v5 offset:8192
    ds_read_b32 v47, v5 offset:8448
    s_waitcnt lgkmcnt(0)
    v_add_u32 v5, 83968, v3
    ds_read_b128 v[100:103], v5
    ds_read_b128 v[104:107], v5 offset:1024
    v_add_u32 v5, 92672, v3
    ds_read_b128 v[108:111], v5
    ds_read_b128 v[112:115], v5 offset:1024
    v_add_u32 v5, 101376, v3
    ds_read_b128 v[116:119], v5
    ds_read_b128 v[120:123], v5 offset:1024
    v_add_u32 v5, 110080, v3
    ds_read_b128 v[124:127], v5
    ds_read_b128 v[128:131], v5 offset:1024
    v_add_u32 v5, 49152, v3
    ds_read_b128 v[132:135], v5
    ds_read_b128 v[136:139], v5 offset:1024
    v_add_u32 v5, 57856, v3
    ds_read_b128 v[140:143], v5
    ds_read_b128 v[144:147], v5 offset:1024
    s_waitcnt lgkmcnt(6)
    v_add_u32 v5, 66560, v3
    ds_read_b128 v[148:151], v5
    ds_read_b128 v[152:155], v5 offset:1024
    v_add_u32 v5, 75264, v3
    ds_read_b128 v[156:159], v5
    ds_read_b128 v[160:163], v5 offset:1024
    v_min3_f32 v12, v40, v41, v42
    v_min3_f32 v12, v12, v43, v44
    v_min3_f32 v12, v12, v45, v46
    v_min_f32 v12, v12, v47
    v_sub_f32 v40, v12, v40
    v_sub_f32 v41, v12, v41
    v_sub_f32 v42, v12, v42
    v_sub_f32 v43, v12, v43
    v_sub_f32 v44, v12, v44
    v_sub_f32 v45, v12, v45
    v_sub_f32 v46, v12, v46
    v_sub_f32 v47, v12, v47
    v_exp_f32 v40, v40
    v_exp_f32 v41, v41
    v_exp_f32 v42, v42
    v_exp_f32 v43, v43
    v_exp_f32 v44, v44
    v_exp_f32 v45, v45
    v_exp_f32 v46, v46
    v_exp_f32 v47, v47
    s_nop 0
    v_mul_f32 v13, v32, v40
    v_fmac_f32 v13, v33, v41
    v_fmac_f32 v13, v34, v42
    v_fmac_f32 v13, v35, v43
    v_fmac_f32 v13, v36, v44
    v_fmac_f32 v13, v37, v45
    v_fmac_f32 v13, v38, v46
    v_fmac_f32 v13, v39, v47
    v_rcp_f32 v13, v13
    s_nop 0
    v_mul_f32 v40, v40, v13
    v_mul_f32 v41, v41, v13
    v_mul_f32 v42, v42, v13
    v_mul_f32 v43, v43, v13
    v_mul_f32 v44, v44, v13
    v_mul_f32 v45, v45, v13
    v_mul_f32 v46, v46, v13
    v_mul_f32 v47, v47, v13
    s_mul_i32 s47, s51, 9
    s_lshl_b32 s57, s52, 2
    s_add_u32 s49, s47, 8
    s_lshl_b32 s49, s49, 7
    s_add_u32 s49, s49, s57
    s_add_u32 s49, s49, s45
    s_lshl_b32 s49, s49, 10
    s_waitcnt lgkmcnt(0)
    v_mul_f32 v100, v100, v40
    v_mul_f32 v101, v101, v40
    v_mul_f32 v102, v102, v40
    v_mul_f32 v103, v103, v40
    v_mul_f32 v104, v104, v40
    v_mul_f32 v105, v105, v40
    v_mul_f32 v106, v106, v40
    v_mul_f32 v107, v107, v40
    v_fmac_f32 v100, v108, v41
    v_fmac_f32 v101, v109, v41
    v_fmac_f32 v102, v110, v41
    v_fmac_f32 v103, v111, v41
    v_fmac_f32 v104, v112, v41
    v_fmac_f32 v105, v113, v41
    v_fmac_f32 v106, v114, v41
    v_fmac_f32 v107, v115, v41
    v_fmac_f32 v100, v116, v42
    v_fmac_f32 v101, v117, v42
    v_fmac_f32 v102, v118, v42
    v_fmac_f32 v103, v119, v42
    v_fmac_f32 v104, v120, v42
    v_fmac_f32 v105, v121, v42
    v_fmac_f32 v106, v122, v42
    v_fmac_f32 v107, v123, v42
    v_fmac_f32 v100, v124, v43
    v_fmac_f32 v101, v125, v43
    v_fmac_f32 v102, v126, v43
    v_fmac_f32 v103, v127, v43
    v_fmac_f32 v104, v128, v43
    v_fmac_f32 v105, v129, v43
    v_fmac_f32 v106, v130, v43
    v_fmac_f32 v107, v131, v43
    v_fmac_f32 v100, v132, v44
    v_fmac_f32 v101, v133, v44
    v_fmac_f32 v102, v134, v44
    v_fmac_f32 v103, v135, v44
    v_fmac_f32 v104, v136, v44
    v_fmac_f32 v105, v137, v44
    v_fmac_f32 v106, v138, v44
    v_fmac_f32 v107, v139, v44
    v_fmac_f32 v100, v140, v45
    v_fmac_f32 v101, v141, v45
    v_fmac_f32 v102, v142, v45
    v_fmac_f32 v103, v143, v45
    v_fmac_f32 v104, v144, v45
    v_fmac_f32 v105, v145, v45
    v_fmac_f32 v106, v146, v45
    v_fmac_f32 v107, v147, v45
    v_fmac_f32 v100, v148, v46
    v_fmac_f32 v101, v149, v46
    v_fmac_f32 v102, v150, v46
    v_fmac_f32 v103, v151, v46
    v_fmac_f32 v104, v152, v46
    v_fmac_f32 v105, v153, v46
    v_fmac_f32 v106, v154, v46
    v_fmac_f32 v107, v155, v46
    v_fmac_f32 v100, v156, v47
    v_fmac_f32 v101, v157, v47
    v_fmac_f32 v102, v158, v47
    v_fmac_f32 v103, v159, v47
    v_fmac_f32 v104, v160, v47
    v_fmac_f32 v105, v161, v47
    v_fmac_f32 v106, v162, v47
    v_fmac_f32 v107, v163, v47
    v_cvt_pk_bf16_f32 v100, v100, v101
    v_cvt_pk_bf16_f32 v101, v102, v103
    v_cvt_pk_bf16_f32 v102, v104, v105
    v_cvt_pk_bf16_f32 v103, v106, v107
    buffer_store_dwordx4 v[100:103], v26, s[40:43], s49 offen sc0 sc1
    s_endpgm
.Lk1_end:
    s_endpgm
.globl oproj_kernel
.p2align 8
.type oproj_kernel,@function
oproj_kernel:
    s_cmp_ge_u32 s2, 216
    s_cbranch_scc1 .Lk2_end
    s_load_dwordx2 s[4:5], s[0:1], 40
    s_load_dwordx2 s[6:7], s[0:1], 56
    v_lshrrev_b32 v1, 6, v0
    v_and_b32 v0, 63, v0
    v_readfirstlane_b32 s44, v1
    s_and_b32 s8, s2, 7
    s_lshr_b32 s9, s2, 3
    s_mul_i32 s10, s9, 43
    s_lshr_b32 s10, s10, 7
    s_mul_i32 s11, s10, 3
    s_sub_u32 s11, s9, s11
    s_mul_i32 s12, s8, 3
    s_add_u32 s12, s12, s11
    s_waitcnt lgkmcnt(0)
    s_mov_b32 s20, s4
    s_mov_b32 s21, s5
    s_mov_b32 s22, 1327104
    s_mov_b32 s23, 0x00020000
    s_mov_b32 s24, s6
    s_mov_b32 s25, s7
    s_mov_b32 s26, 33554432
    s_mov_b32 s27, 0x00020000
    v_lshlrev_b32 v2, 4, v0
    s_lshl_b32 s13, s44, 14
    s_mul_i32 s14, s12, 3
    s_lshl_b32 s14, s14, 17
    s_add_u32 s14, s14, s13
    s_lshl_b32 s15, s10, 19
    s_add_u32 s15, s15, s13
    s_add_u32 s15, s15, 16777216
    s_add_u32 s28, s14, 0
    s_add_u32 s29, s14, 131072
    s_add_u32 s30, s14, 262144
    s_add_u32 s31, s15, 0
    s_add_u32 s32, s15, 131072
    s_add_u32 s33, s15, 262144
    s_add_u32 s34, s15, 393216
    s_mov_b32 s16, 0
    s_lshl_b32 s16, s16, 10
    v_add_u32 v7, s16, v2
    buffer_load_dwordx4 v[56:59], v7, s[24:27], s28 offen
    buffer_load_dwordx4 v[60:63], v7, s[24:27], s29 offen
    buffer_load_dwordx4 v[64:67], v7, s[24:27], s30 offen
    buffer_load_dwordx4 v[68:71], v7, s[24:27], s31 offen
    buffer_load_dwordx4 v[72:75], v7, s[24:27], s32 offen
    buffer_load_dwordx4 v[76:79], v7, s[24:27], s33 offen
    buffer_load_dwordx4 v[80:83], v7, s[24:27], s34 offen
    s_add_u32 s16, s16, 1024
    s_and_b32 s16, s16, 0x3fff
    v_add_u32 v7, s16, v2
    buffer_load_dwordx4 v[84:87], v7, s[24:27], s28 offen
    buffer_load_dwordx4 v[88:91], v7, s[24:27], s29 offen
    buffer_load_dwordx4 v[92:95], v7, s[24:27], s30 offen
    buffer_load_dwordx4 v[96:99], v7, s[24:27], s31 offen
    buffer_load_dwordx4 v[100:103], v7, s[24:27], s32 offen
    buffer_load_dwordx4 v[104:107], v7, s[24:27], s33 offen
    buffer_load_dwordx4 v[108:111], v7, s[24:27], s34 offen
    s_add_u32 s16, s16, 1024
    s_and_b32 s16, s16, 0x3fff
    v_add_u32 v7, s16, v2
    buffer_load_dwordx4 v[112:115], v7, s[24:27], s28 offen
    buffer_load_dwordx4 v[116:119], v7, s[24:27], s29 offen
    buffer_load_dwordx4 v[120:123], v7, s[24:27], s30 offen
    buffer_load_dwordx4 v[124:127], v7, s[24:27], s31 offen
    buffer_load_dwordx4 v[128:131], v7, s[24:27], s32 offen
    buffer_load_dwordx4 v[132:135], v7, s[24:27], s33 offen
    buffer_load_dwordx4 v[136:139], v7, s[24:27], s34 offen
    s_add_u32 s16, s16, 1024
    s_and_b32 s16, s16, 0x3fff
    v_add_u32 v7, s16, v2
    buffer_load_dwordx4 v[140:143], v7, s[24:27], s28 offen
    buffer_load_dwordx4 v[144:147], v7, s[24:27], s29 offen
    buffer_load_dwordx4 v[148:151], v7, s[24:27], s30 offen
    buffer_load_dwordx4 v[152:155], v7, s[24:27], s31 offen
    buffer_load_dwordx4 v[156:159], v7, s[24:27], s32 offen
    buffer_load_dwordx4 v[160:163], v7, s[24:27], s33 offen
    buffer_load_dwordx4 v[164:167], v7, s[24:27], s34 offen
    s_add_u32 s16, s16, 1024
    s_and_b32 s16, s16, 0x3fff
    v_add_u32 v7, s16, v2
    buffer_load_dwordx4 v[168:171], v7, s[24:27], s28 offen
    buffer_load_dwordx4 v[172:175], v7, s[24:27], s29 offen
    buffer_load_dwordx4 v[176:179], v7, s[24:27], s30 offen
    buffer_load_dwordx4 v[180:183], v7, s[24:27], s31 offen
    buffer_load_dwordx4 v[184:187], v7, s[24:27], s32 offen
    buffer_load_dwordx4 v[188:191], v7, s[24:27], s33 offen
    buffer_load_dwordx4 v[192:195], v7, s[24:27], s34 offen
    s_add_u32 s16, s16, 1024
    s_and_b32 s16, s16, 0x3fff
    v_add_u32 v7, s16, v2
    buffer_load_dwordx4 v[196:199], v7, s[24:27], s28 offen
    buffer_load_dwordx4 v[200:203], v7, s[24:27], s29 offen
    buffer_load_dwordx4 v[204:207], v7, s[24:27], s30 offen
    buffer_load_dwordx4 v[208:211], v7, s[24:27], s31 offen
    buffer_load_dwordx4 v[212:215], v7, s[24:27], s32 offen
    buffer_load_dwordx4 v[216:219], v7, s[24:27], s33 offen
    buffer_load_dwordx4 v[220:223], v7, s[24:27], s34 offen
    s_add_u32 s16, s16, 1024
    s_and_b32 s16, s16, 0x3fff
    v_add_u32 v7, s16, v2
    buffer_load_dwordx4 v[224:227], v7, s[24:27], s28 offen
    buffer_load_dwordx4 v[228:231], v7, s[24:27], s29 offen
    buffer_load_dwordx4 v[232:235], v7, s[24:27], s30 offen
    buffer_load_dwordx4 v[236:239], v7, s[24:27], s31 offen
    buffer_load_dwordx4 v[240:243], v7, s[24:27], s32 offen
    buffer_load_dwordx4 v[244:247], v7, s[24:27], s33 offen
    buffer_load_dwordx4 v[248:251], v7, s[24:27], s34 offen
    s_add_u32 s16, s16, 1024
    s_and_b32 s16, s16, 0x3fff
    s_waitcnt vmcnt(42)
    v_mfma_f32_16x16x32_bf16 v[8:11], v[68:71], v[56:59], 0
    v_mfma_f32_16x16x32_bf16 v[12:15], v[72:75], v[56:59], 0
    v_mfma_f32_16x16x32_bf16 v[16:19], v[76:79], v[56:59], 0
    v_mfma_f32_16x16x32_bf16 v[20:23], v[80:83], v[56:59], 0
    v_mfma_f32_16x16x32_bf16 v[24:27], v[68:71], v[60:63], 0
    v_mfma_f32_16x16x32_bf16 v[28:31], v[72:75], v[60:63], 0
    v_mfma_f32_16x16x32_bf16 v[32:35], v[76:79], v[60:63], 0
    v_mfma_f32_16x16x32_bf16 v[36:39], v[80:83], v[60:63], 0
    v_mfma_f32_16x16x32_bf16 v[40:43], v[68:71], v[64:67], 0
    v_mfma_f32_16x16x32_bf16 v[44:47], v[72:75], v[64:67], 0
    v_mfma_f32_16x16x32_bf16 v[48:51], v[76:79], v[64:67], 0
    v_mfma_f32_16x16x32_bf16 v[52:55], v[80:83], v[64:67], 0
    v_add_u32 v7, s16, v2
    buffer_load_dwordx4 v[56:59], v7, s[24:27], s28 offen
    buffer_load_dwordx4 v[60:63], v7, s[24:27], s29 offen
    buffer_load_dwordx4 v[64:67], v7, s[24:27], s30 offen
    buffer_load_dwordx4 v[68:71], v7, s[24:27], s31 offen
    buffer_load_dwordx4 v[72:75], v7, s[24:27], s32 offen
    buffer_load_dwordx4 v[76:79], v7, s[24:27], s33 offen
    buffer_load_dwordx4 v[80:83], v7, s[24:27], s34 offen
    s_add_u32 s16, s16, 1024
    s_and_b32 s16, s16, 0x3fff
    s_waitcnt vmcnt(42)
    v_mfma_f32_16x16x32_bf16 v[8:11], v[96:99], v[84:87], v[8:11]
    v_mfma_f32_16x16x32_bf16 v[12:15], v[100:103], v[84:87], v[12:15]
    v_mfma_f32_16x16x32_bf16 v[16:19], v[104:107], v[84:87], v[16:19]
    v_mfma_f32_16x16x32_bf16 v[20:23], v[108:111], v[84:87], v[20:23]
    v_mfma_f32_16x16x32_bf16 v[24:27], v[96:99], v[88:91], v[24:27]
    v_mfma_f32_16x16x32_bf16 v[28:31], v[100:103], v[88:91], v[28:31]
    v_mfma_f32_16x16x32_bf16 v[32:35], v[104:107], v[88:91], v[32:35]
    v_mfma_f32_16x16x32_bf16 v[36:39], v[108:111], v[88:91], v[36:39]
    v_mfma_f32_16x16x32_bf16 v[40:43], v[96:99], v[92:95], v[40:43]
    v_mfma_f32_16x16x32_bf16 v[44:47], v[100:103], v[92:95], v[44:47]
    v_mfma_f32_16x16x32_bf16 v[48:51], v[104:107], v[92:95], v[48:51]
    v_mfma_f32_16x16x32_bf16 v[52:55], v[108:111], v[92:95], v[52:55]
    v_add_u32 v7, s16, v2
    buffer_load_dwordx4 v[84:87], v7, s[24:27], s28 offen
    buffer_load_dwordx4 v[88:91], v7, s[24:27], s29 offen
    buffer_load_dwordx4 v[92:95], v7, s[24:27], s30 offen
    buffer_load_dwordx4 v[96:99], v7, s[24:27], s31 offen
    buffer_load_dwordx4 v[100:103], v7, s[24:27], s32 offen
    buffer_load_dwordx4 v[104:107], v7, s[24:27], s33 offen
    buffer_load_dwordx4 v[108:111], v7, s[24:27], s34 offen
    s_add_u32 s16, s16, 1024
    s_and_b32 s16, s16, 0x3fff
    s_waitcnt vmcnt(42)
    v_mfma_f32_16x16x32_bf16 v[8:11], v[124:127], v[112:115], v[8:11]
    v_mfma_f32_16x16x32_bf16 v[12:15], v[128:131], v[112:115], v[12:15]
    v_mfma_f32_16x16x32_bf16 v[16:19], v[132:135], v[112:115], v[16:19]
    v_mfma_f32_16x16x32_bf16 v[20:23], v[136:139], v[112:115], v[20:23]
    v_mfma_f32_16x16x32_bf16 v[24:27], v[124:127], v[116:119], v[24:27]
    v_mfma_f32_16x16x32_bf16 v[28:31], v[128:131], v[116:119], v[28:31]
    v_mfma_f32_16x16x32_bf16 v[32:35], v[132:135], v[116:119], v[32:35]
    v_mfma_f32_16x16x32_bf16 v[36:39], v[136:139], v[116:119], v[36:39]
    v_mfma_f32_16x16x32_bf16 v[40:43], v[124:127], v[120:123], v[40:43]
    v_mfma_f32_16x16x32_bf16 v[44:47], v[128:131], v[120:123], v[44:47]
    v_mfma_f32_16x16x32_bf16 v[48:51], v[132:135], v[120:123], v[48:51]
    v_mfma_f32_16x16x32_bf16 v[52:55], v[136:139], v[120:123], v[52:55]
    v_add_u32 v7, s16, v2
    buffer_load_dwordx4 v[112:115], v7, s[24:27], s28 offen
    buffer_load_dwordx4 v[116:119], v7, s[24:27], s29 offen
    buffer_load_dwordx4 v[120:123], v7, s[24:27], s30 offen
    buffer_load_dwordx4 v[124:127], v7, s[24:27], s31 offen
    buffer_load_dwordx4 v[128:131], v7, s[24:27], s32 offen
    buffer_load_dwordx4 v[132:135], v7, s[24:27], s33 offen
    buffer_load_dwordx4 v[136:139], v7, s[24:27], s34 offen
    s_add_u32 s16, s16, 1024
    s_and_b32 s16, s16, 0x3fff
    s_waitcnt vmcnt(42)
    v_mfma_f32_16x16x32_bf16 v[8:11], v[152:155], v[140:143], v[8:11]
    v_mfma_f32_16x16x32_bf16 v[12:15], v[156:159], v[140:143], v[12:15]
    v_mfma_f32_16x16x32_bf16 v[16:19], v[160:163], v[140:143], v[16:19]
    v_mfma_f32_16x16x32_bf16 v[20:23], v[164:167], v[140:143], v[20:23]
    v_mfma_f32_16x16x32_bf16 v[24:27], v[152:155], v[144:147], v[24:27]
    v_mfma_f32_16x16x32_bf16 v[28:31], v[156:159], v[144:147], v[28:31]
    v_mfma_f32_16x16x32_bf16 v[32:35], v[160:163], v[144:147], v[32:35]
    v_mfma_f32_16x16x32_bf16 v[36:39], v[164:167], v[144:147], v[36:39]
    v_mfma_f32_16x16x32_bf16 v[40:43], v[152:155], v[148:151], v[40:43]
    v_mfma_f32_16x16x32_bf16 v[44:47], v[156:159], v[148:151], v[44:47]
    v_mfma_f32_16x16x32_bf16 v[48:51], v[160:163], v[148:151], v[48:51]
    v_mfma_f32_16x16x32_bf16 v[52:55], v[164:167], v[148:151], v[52:55]
    v_add_u32 v7, s16, v2
    buffer_load_dwordx4 v[140:143], v7, s[24:27], s28 offen
    buffer_load_dwordx4 v[144:147], v7, s[24:27], s29 offen
    buffer_load_dwordx4 v[148:151], v7, s[24:27], s30 offen
    buffer_load_dwordx4 v[152:155], v7, s[24:27], s31 offen
    buffer_load_dwordx4 v[156:159], v7, s[24:27], s32 offen
    buffer_load_dwordx4 v[160:163], v7, s[24:27], s33 offen
    buffer_load_dwordx4 v[164:167], v7, s[24:27], s34 offen
    s_add_u32 s16, s16, 1024
    s_and_b32 s16, s16, 0x3fff
    s_waitcnt vmcnt(42)
    v_mfma_f32_16x16x32_bf16 v[8:11], v[180:183], v[168:171], v[8:11]
    v_mfma_f32_16x16x32_bf16 v[12:15], v[184:187], v[168:171], v[12:15]
    v_mfma_f32_16x16x32_bf16 v[16:19], v[188:191], v[168:171], v[16:19]
    v_mfma_f32_16x16x32_bf16 v[20:23], v[192:195], v[168:171], v[20:23]
    v_mfma_f32_16x16x32_bf16 v[24:27], v[180:183], v[172:175], v[24:27]
    v_mfma_f32_16x16x32_bf16 v[28:31], v[184:187], v[172:175], v[28:31]
    v_mfma_f32_16x16x32_bf16 v[32:35], v[188:191], v[172:175], v[32:35]
    v_mfma_f32_16x16x32_bf16 v[36:39], v[192:195], v[172:175], v[36:39]
    v_mfma_f32_16x16x32_bf16 v[40:43], v[180:183], v[176:179], v[40:43]
    v_mfma_f32_16x16x32_bf16 v[44:47], v[184:187], v[176:179], v[44:47]
    v_mfma_f32_16x16x32_bf16 v[48:51], v[188:191], v[176:179], v[48:51]
    v_mfma_f32_16x16x32_bf16 v[52:55], v[192:195], v[176:179], v[52:55]
    v_add_u32 v7, s16, v2
    buffer_load_dwordx4 v[168:171], v7, s[24:27], s28 offen
    buffer_load_dwordx4 v[172:175], v7, s[24:27], s29 offen
    buffer_load_dwordx4 v[176:179], v7, s[24:27], s30 offen
    buffer_load_dwordx4 v[180:183], v7, s[24:27], s31 offen
    buffer_load_dwordx4 v[184:187], v7, s[24:27], s32 offen
    buffer_load_dwordx4 v[188:191], v7, s[24:27], s33 offen
    buffer_load_dwordx4 v[192:195], v7, s[24:27], s34 offen
    s_add_u32 s16, s16, 1024
    s_and_b32 s16, s16, 0x3fff
    s_waitcnt vmcnt(42)
    v_mfma_f32_16x16x32_bf16 v[8:11], v[208:211], v[196:199], v[8:11]
    v_mfma_f32_16x16x32_bf16 v[12:15], v[212:215], v[196:199], v[12:15]
    v_mfma_f32_16x16x32_bf16 v[16:19], v[216:219], v[196:199], v[16:19]
    v_mfma_f32_16x16x32_bf16 v[20:23], v[220:223], v[196:199], v[20:23]
    v_mfma_f32_16x16x32_bf16 v[24:27], v[208:211], v[200:203], v[24:27]
    v_mfma_f32_16x16x32_bf16 v[28:31], v[212:215], v[200:203], v[28:31]
    v_mfma_f32_16x16x32_bf16 v[32:35], v[216:219], v[200:203], v[32:35]
    v_mfma_f32_16x16x32_bf16 v[36:39], v[220:223], v[200:203], v[36:39]
    v_mfma_f32_16x16x32_bf16 v[40:43], v[208:211], v[204:207], v[40:43]
    v_mfma_f32_16x16x32_bf16 v[44:47], v[212:215], v[204:207], v[44:47]
    v_mfma_f32_16x16x32_bf16 v[48:51], v[216:219], v[204:207], v[48:51]
    v_mfma_f32_16x16x32_bf16 v[52:55], v[220:223], v[204:207], v[52:55]
    v_add_u32 v7, s16, v2
    buffer_load_dwordx4 v[196:199], v7, s[24:27], s28 offen
    buffer_load_dwordx4 v[200:203], v7, s[24:27], s29 offen
    buffer_load_dwordx4 v[204:207], v7, s[24:27], s30 offen
    buffer_load_dwordx4 v[208:211], v7, s[24:27], s31 offen
    buffer_load_dwordx4 v[212:215], v7, s[24:27], s32 offen
    buffer_load_dwordx4 v[216:219], v7, s[24:27], s33 offen
    buffer_load_dwordx4 v[220:223], v7, s[24:27], s34 offen
    s_add_u32 s16, s16, 1024
    s_and_b32 s16, s16, 0x3fff
    s_waitcnt vmcnt(42)
    v_mfma_f32_16x16x32_bf16 v[8:11], v[236:239], v[224:227], v[8:11]
    v_mfma_f32_16x16x32_bf16 v[12:15], v[240:243], v[224:227], v[12:15]
    v_mfma_f32_16x16x32_bf16 v[16:19], v[244:247], v[224:227], v[16:19]
    v_mfma_f32_16x16x32_bf16 v[20:23], v[248:251], v[224:227], v[20:23]
    v_mfma_f32_16x16x32_bf16 v[24:27], v[236:239], v[228:231], v[24:27]
    v_mfma_f32_16x16x32_bf16 v[28:31], v[240:243], v[228:231], v[28:31]
    v_mfma_f32_16x16x32_bf16 v[32:35], v[244:247], v[228:231], v[32:35]
    v_mfma_f32_16x16x32_bf16 v[36:39], v[248:251], v[228:231], v[36:39]
    v_mfma_f32_16x16x32_bf16 v[40:43], v[236:239], v[232:235], v[40:43]
    v_mfma_f32_16x16x32_bf16 v[44:47], v[240:243], v[232:235], v[44:47]
    v_mfma_f32_16x16x32_bf16 v[48:51], v[244:247], v[232:235], v[48:51]
    v_mfma_f32_16x16x32_bf16 v[52:55], v[248:251], v[232:235], v[52:55]
    v_add_u32 v7, s16, v2
    buffer_load_dwordx4 v[224:227], v7, s[24:27], s28 offen
    buffer_load_dwordx4 v[228:231], v7, s[24:27], s29 offen
    buffer_load_dwordx4 v[232:235], v7, s[24:27], s30 offen
    buffer_load_dwordx4 v[236:239], v7, s[24:27], s31 offen
    buffer_load_dwordx4 v[240:243], v7, s[24:27], s32 offen
    buffer_load_dwordx4 v[244:247], v7, s[24:27], s33 offen
    buffer_load_dwordx4 v[248:251], v7, s[24:27], s34 offen
    s_add_u32 s16, s16, 1024
    s_and_b32 s16, s16, 0x3fff
    s_waitcnt vmcnt(42)
    v_mfma_f32_16x16x32_bf16 v[8:11], v[68:71], v[56:59], v[8:11]
    v_mfma_f32_16x16x32_bf16 v[12:15], v[72:75], v[56:59], v[12:15]
    v_mfma_f32_16x16x32_bf16 v[16:19], v[76:79], v[56:59], v[16:19]
    v_mfma_f32_16x16x32_bf16 v[20:23], v[80:83], v[56:59], v[20:23]
    v_mfma_f32_16x16x32_bf16 v[24:27], v[68:71], v[60:63], v[24:27]
    v_mfma_f32_16x16x32_bf16 v[28:31], v[72:75], v[60:63], v[28:31]
    v_mfma_f32_16x16x32_bf16 v[32:35], v[76:79], v[60:63], v[32:35]
    v_mfma_f32_16x16x32_bf16 v[36:39], v[80:83], v[60:63], v[36:39]
    v_mfma_f32_16x16x32_bf16 v[40:43], v[68:71], v[64:67], v[40:43]
    v_mfma_f32_16x16x32_bf16 v[44:47], v[72:75], v[64:67], v[44:47]
    v_mfma_f32_16x16x32_bf16 v[48:51], v[76:79], v[64:67], v[48:51]
    v_mfma_f32_16x16x32_bf16 v[52:55], v[80:83], v[64:67], v[52:55]
    v_add_u32 v7, s16, v2
    buffer_load_dwordx4 v[56:59], v7, s[24:27], s28 offen
    buffer_load_dwordx4 v[60:63], v7, s[24:27], s29 offen
    buffer_load_dwordx4 v[64:67], v7, s[24:27], s30 offen
    buffer_load_dwordx4 v[68:71], v7, s[24:27], s31 offen
    buffer_load_dwordx4 v[72:75], v7, s[24:27], s32 offen
    buffer_load_dwordx4 v[76:79], v7, s[24:27], s33 offen
    buffer_load_dwordx4 v[80:83], v7, s[24:27], s34 offen
    s_add_u32 s16, s16, 1024
    s_and_b32 s16, s16, 0x3fff
    s_waitcnt vmcnt(42)
    v_mfma_f32_16x16x32_bf16 v[8:11], v[96:99], v[84:87], v[8:11]
    v_mfma_f32_16x16x32_bf16 v[12:15], v[100:103], v[84:87], v[12:15]
    v_mfma_f32_16x16x32_bf16 v[16:19], v[104:107], v[84:87], v[16:19]
    v_mfma_f32_16x16x32_bf16 v[20:23], v[108:111], v[84:87], v[20:23]
    v_mfma_f32_16x16x32_bf16 v[24:27], v[96:99], v[88:91], v[24:27]
    v_mfma_f32_16x16x32_bf16 v[28:31], v[100:103], v[88:91], v[28:31]
    v_mfma_f32_16x16x32_bf16 v[32:35], v[104:107], v[88:91], v[32:35]
    v_mfma_f32_16x16x32_bf16 v[36:39], v[108:111], v[88:91], v[36:39]
    v_mfma_f32_16x16x32_bf16 v[40:43], v[96:99], v[92:95], v[40:43]
    v_mfma_f32_16x16x32_bf16 v[44:47], v[100:103], v[92:95], v[44:47]
    v_mfma_f32_16x16x32_bf16 v[48:51], v[104:107], v[92:95], v[48:51]
    v_mfma_f32_16x16x32_bf16 v[52:55], v[108:111], v[92:95], v[52:55]
    v_add_u32 v7, s16, v2
    buffer_load_dwordx4 v[84:87], v7, s[24:27], s28 offen
    buffer_load_dwordx4 v[88:91], v7, s[24:27], s29 offen
    buffer_load_dwordx4 v[92:95], v7, s[24:27], s30 offen
    buffer_load_dwordx4 v[96:99], v7, s[24:27], s31 offen
    buffer_load_dwordx4 v[100:103], v7, s[24:27], s32 offen
    buffer_load_dwordx4 v[104:107], v7, s[24:27], s33 offen
    buffer_load_dwordx4 v[108:111], v7, s[24:27], s34 offen
    s_add_u32 s16, s16, 1024
    s_and_b32 s16, s16, 0x3fff
    s_waitcnt vmcnt(42)
    v_mfma_f32_16x16x32_bf16 v[8:11], v[124:127], v[112:115], v[8:11]
    v_mfma_f32_16x16x32_bf16 v[12:15], v[128:131], v[112:115], v[12:15]
    v_mfma_f32_16x16x32_bf16 v[16:19], v[132:135], v[112:115], v[16:19]
    v_mfma_f32_16x16x32_bf16 v[20:23], v[136:139], v[112:115], v[20:23]
    v_mfma_f32_16x16x32_bf16 v[24:27], v[124:127], v[116:119], v[24:27]
    v_mfma_f32_16x16x32_bf16 v[28:31], v[128:131], v[116:119], v[28:31]
    v_mfma_f32_16x16x32_bf16 v[32:35], v[132:135], v[116:119], v[32:35]
    v_mfma_f32_16x16x32_bf16 v[36:39], v[136:139], v[116:119], v[36:39]
    v_mfma_f32_16x16x32_bf16 v[40:43], v[124:127], v[120:123], v[40:43]
    v_mfma_f32_16x16x32_bf16 v[44:47], v[128:131], v[120:123], v[44:47]
    v_mfma_f32_16x16x32_bf16 v[48:51], v[132:135], v[120:123], v[48:51]
    v_mfma_f32_16x16x32_bf16 v[52:55], v[136:139], v[120:123], v[52:55]
    s_waitcnt vmcnt(35)
    v_mfma_f32_16x16x32_bf16 v[8:11], v[152:155], v[140:143], v[8:11]
    v_mfma_f32_16x16x32_bf16 v[12:15], v[156:159], v[140:143], v[12:15]
    v_mfma_f32_16x16x32_bf16 v[16:19], v[160:163], v[140:143], v[16:19]
    v_mfma_f32_16x16x32_bf16 v[20:23], v[164:167], v[140:143], v[20:23]
    v_mfma_f32_16x16x32_bf16 v[24:27], v[152:155], v[144:147], v[24:27]
    v_mfma_f32_16x16x32_bf16 v[28:31], v[156:159], v[144:147], v[28:31]
    v_mfma_f32_16x16x32_bf16 v[32:35], v[160:163], v[144:147], v[32:35]
    v_mfma_f32_16x16x32_bf16 v[36:39], v[164:167], v[144:147], v[36:39]
    v_mfma_f32_16x16x32_bf16 v[40:43], v[152:155], v[148:151], v[40:43]
    v_mfma_f32_16x16x32_bf16 v[44:47], v[156:159], v[148:151], v[44:47]
    v_mfma_f32_16x16x32_bf16 v[48:51], v[160:163], v[148:151], v[48:51]
    v_mfma_f32_16x16x32_bf16 v[52:55], v[164:167], v[148:151], v[52:55]
    s_waitcnt vmcnt(28)
    v_mfma_f32_16x16x32_bf16 v[8:11], v[180:183], v[168:171], v[8:11]
    v_mfma_f32_16x16x32_bf16 v[12:15], v[184:187], v[168:171], v[12:15]
    v_mfma_f32_16x16x32_bf16 v[16:19], v[188:191], v[168:171], v[16:19]
    v_mfma_f32_16x16x32_bf16 v[20:23], v[192:195], v[168:171], v[20:23]
    v_mfma_f32_16x16x32_bf16 v[24:27], v[180:183], v[172:175], v[24:27]
    v_mfma_f32_16x16x32_bf16 v[28:31], v[184:187], v[172:175], v[28:31]
    v_mfma_f32_16x16x32_bf16 v[32:35], v[188:191], v[172:175], v[32:35]
    v_mfma_f32_16x16x32_bf16 v[36:39], v[192:195], v[172:175], v[36:39]
    v_mfma_f32_16x16x32_bf16 v[40:43], v[180:183], v[176:179], v[40:43]
    v_mfma_f32_16x16x32_bf16 v[44:47], v[184:187], v[176:179], v[44:47]
    v_mfma_f32_16x16x32_bf16 v[48:51], v[188:191], v[176:179], v[48:51]
    v_mfma_f32_16x16x32_bf16 v[52:55], v[192:195], v[176:179], v[52:55]
    s_waitcnt vmcnt(21)
    v_mfma_f32_16x16x32_bf16 v[8:11], v[208:211], v[196:199], v[8:11]
    v_mfma_f32_16x16x32_bf16 v[12:15], v[212:215], v[196:199], v[12:15]
    v_mfma_f32_16x16x32_bf16 v[16:19], v[216:219], v[196:199], v[16:19]
    v_mfma_f32_16x16x32_bf16 v[20:23], v[220:223], v[196:199], v[20:23]
    v_mfma_f32_16x16x32_bf16 v[24:27], v[208:211], v[200:203], v[24:27]
    v_mfma_f32_16x16x32_bf16 v[28:31], v[212:215], v[200:203], v[28:31]
    v_mfma_f32_16x16x32_bf16 v[32:35], v[216:219], v[200:203], v[32:35]
    v_mfma_f32_16x16x32_bf16 v[36:39], v[220:223], v[200:203], v[36:39]
    v_mfma_f32_16x16x32_bf16 v[40:43], v[208:211], v[204:207], v[40:43]
    v_mfma_f32_16x16x32_bf16 v[44:47], v[212:215], v[204:207], v[44:47]
    v_mfma_f32_16x16x32_bf16 v[48:51], v[216:219], v[204:207], v[48:51]
    v_mfma_f32_16x16x32_bf16 v[52:55], v[220:223], v[204:207], v[52:55]
    s_waitcnt vmcnt(14)
    v_mfma_f32_16x16x32_bf16 v[8:11], v[236:239], v[224:227], v[8:11]
    v_mfma_f32_16x16x32_bf16 v[12:15], v[240:243], v[224:227], v[12:15]
    v_mfma_f32_16x16x32_bf16 v[16:19], v[244:247], v[224:227], v[16:19]
    v_mfma_f32_16x16x32_bf16 v[20:23], v[248:251], v[224:227], v[20:23]
    v_mfma_f32_16x16x32_bf16 v[24:27], v[236:239], v[228:231], v[24:27]
    v_mfma_f32_16x16x32_bf16 v[28:31], v[240:243], v[228:231], v[28:31]
    v_mfma_f32_16x16x32_bf16 v[32:35], v[244:247], v[228:231], v[32:35]
    v_mfma_f32_16x16x32_bf16 v[36:39], v[248:251], v[228:231], v[36:39]
    v_mfma_f32_16x16x32_bf16 v[40:43], v[236:239], v[232:235], v[40:43]
    v_mfma_f32_16x16x32_bf16 v[44:47], v[240:243], v[232:235], v[44:47]
    v_mfma_f32_16x16x32_bf16 v[48:51], v[244:247], v[232:235], v[48:51]
    v_mfma_f32_16x16x32_bf16 v[52:55], v[248:251], v[232:235], v[52:55]
    s_waitcnt vmcnt(7)
    v_mfma_f32_16x16x32_bf16 v[8:11], v[68:71], v[56:59], v[8:11]
    v_mfma_f32_16x16x32_bf16 v[12:15], v[72:75], v[56:59], v[12:15]
    v_mfma_f32_16x16x32_bf16 v[16:19], v[76:79], v[56:59], v[16:19]
    v_mfma_f32_16x16x32_bf16 v[20:23], v[80:83], v[56:59], v[20:23]
    v_mfma_f32_16x16x32_bf16 v[24:27], v[68:71], v[60:63], v[24:27]
    v_mfma_f32_16x16x32_bf16 v[28:31], v[72:75], v[60:63], v[28:31]
    v_mfma_f32_16x16x32_bf16 v[32:35], v[76:79], v[60:63], v[32:35]
    v_mfma_f32_16x16x32_bf16 v[36:39], v[80:83], v[60:63], v[36:39]
    v_mfma_f32_16x16x32_bf16 v[40:43], v[68:71], v[64:67], v[40:43]
    v_mfma_f32_16x16x32_bf16 v[44:47], v[72:75], v[64:67], v[44:47]
    v_mfma_f32_16x16x32_bf16 v[48:51], v[76:79], v[64:67], v[48:51]
    v_mfma_f32_16x16x32_bf16 v[52:55], v[80:83], v[64:67], v[52:55]
    s_waitcnt vmcnt(0)
    v_mfma_f32_16x16x32_bf16 v[8:11], v[96:99], v[84:87], v[8:11]
    v_mfma_f32_16x16x32_bf16 v[12:15], v[100:103], v[84:87], v[12:15]
    v_mfma_f32_16x16x32_bf16 v[16:19], v[104:107], v[84:87], v[16:19]
    v_mfma_f32_16x16x32_bf16 v[20:23], v[108:111], v[84:87], v[20:23]
    v_mfma_f32_16x16x32_bf16 v[24:27], v[96:99], v[88:91], v[24:27]
    v_mfma_f32_16x16x32_bf16 v[28:31], v[100:103], v[88:91], v[28:31]
    v_mfma_f32_16x16x32_bf16 v[32:35], v[104:107], v[88:91], v[32:35]
    v_mfma_f32_16x16x32_bf16 v[36:39], v[108:111], v[88:91], v[36:39]
    v_mfma_f32_16x16x32_bf16 v[40:43], v[96:99], v[92:95], v[40:43]
    v_mfma_f32_16x16x32_bf16 v[44:47], v[100:103], v[92:95], v[44:47]
    v_mfma_f32_16x16x32_bf16 v[48:51], v[104:107], v[92:95], v[48:51]
    v_mfma_f32_16x16x32_bf16 v[52:55], v[108:111], v[92:95], v[52:55]
    s_nop 7
    s_nop 1
    s_mul_i32 s13, s44, 12288
    v_add_u32 v3, s13, v2
    ds_write_b128 v3, v[8:11] offset:0
    ds_write_b128 v3, v[12:15] offset:1024
    ds_write_b128 v3, v[16:19] offset:2048
    ds_write_b128 v3, v[20:23] offset:3072
    ds_write_b128 v3, v[24:27] offset:4096
    ds_write_b128 v3, v[28:31] offset:5120
    ds_write_b128 v3, v[32:35] offset:6144
    ds_write_b128 v3, v[36:39] offset:7168
    ds_write_b128 v3, v[40:43] offset:8192
    ds_write_b128 v3, v[44:47] offset:9216
    ds_write_b128 v3, v[48:51] offset:10240
    ds_write_b128 v3, v[52:55] offset:11264
    s_waitcnt lgkmcnt(0)
    s_barrier
    s_cmp_ge_u32 s44, 6
    s_cbranch_scc1 .Lk2_end
    s_lshl_b32 s13, s44, 11
    v_add_u32 v3, s13, v2
    v_add_u32 v4, 49152, v3
    ds_read_b128 v[64:67], v3 offset:0
    ds_read_b128 v[68:71], v3 offset:1024
    ds_read_b128 v[72:75], v3 offset:12288
    ds_read_b128 v[76:79], v3 offset:13312
    ds_read_b128 v[80:83], v3 offset:24576
    ds_read_b128 v[84:87], v3 offset:25600
    ds_read_b128 v[88:91], v3 offset:36864
    ds_read_b128 v[92:95], v3 offset:37888
    ds_read_b128 v[96:99], v4 offset:0
    ds_read_b128 v[100:103], v4 offset:1024
    ds_read_b128 v[104:107], v4 offset:12288
    ds_read_b128 v[108:111], v4 offset:13312
    ds_read_b128 v[112:115], v4 offset:24576
    ds_read_b128 v[116:119], v4 offset:25600
    ds_read_b128 v[120:123], v4 offset:36864
    ds_read_b128 v[124:127], v4 offset:37888
    s_waitcnt lgkmcnt(0)
    v_add_f32 v64, v64, v72
    v_add_f32 v65, v65, v73
    v_add_f32 v66, v66, v74
    v_add_f32 v67, v67, v75
    v_add_f32 v68, v68, v76
    v_add_f32 v69, v69, v77
    v_add_f32 v70, v70, v78
    v_add_f32 v71, v71, v79
    v_add_f32 v64, v64, v80
    v_add_f32 v65, v65, v81
    v_add_f32 v66, v66, v82
    v_add_f32 v67, v67, v83
    v_add_f32 v68, v68, v84
    v_add_f32 v69, v69, v85
    v_add_f32 v70, v70, v86
    v_add_f32 v71, v71, v87
    v_add_f32 v64, v64, v88
    v_add_f32 v65, v65, v89
    v_add_f32 v66, v66, v90
    v_add_f32 v67, v67, v91
    v_add_f32 v68, v68, v92
    v_add_f32 v69, v69, v93
    v_add_f32 v70, v70, v94
    v_add_f32 v71, v71, v95
    v_add_f32 v64, v64, v96
    v_add_f32 v65, v65, v97
    v_add_f32 v66, v66, v98
    v_add_f32 v67, v67, v99
    v_add_f32 v68, v68, v100
    v_add_f32 v69, v69, v101
    v_add_f32 v70, v70, v102
    v_add_f32 v71, v71, v103
    v_add_f32 v64, v64, v104
    v_add_f32 v65, v65, v105
    v_add_f32 v66, v66, v106
    v_add_f32 v67, v67, v107
    v_add_f32 v68, v68, v108
    v_add_f32 v69, v69, v109
    v_add_f32 v70, v70, v110
    v_add_f32 v71, v71, v111
    v_add_f32 v64, v64, v112
    v_add_f32 v65, v65, v113
    v_add_f32 v66, v66, v114
    v_add_f32 v67, v67, v115
    v_add_f32 v68, v68, v116
    v_add_f32 v69, v69, v117
    v_add_f32 v70, v70, v118
    v_add_f32 v71, v71, v119
    v_add_f32 v64, v64, v120
    v_add_f32 v65, v65, v121
    v_add_f32 v66, v66, v122
    v_add_f32 v67, v67, v123
    v_add_f32 v68, v68, v124
    v_add_f32 v69, v69, v125
    v_add_f32 v70, v70, v126
    v_add_f32 v71, v71, v127
    v_cvt_pk_bf16_f32 v8, v64, v68
    v_cvt_pk_bf16_f32 v9, v65, v69
    v_cvt_pk_bf16_f32 v10, v66, v70
    v_cvt_pk_bf16_f32 v11, v67, v71
    s_lshr_b32 s13, s44, 1
    s_mul_i32 s14, s12, 3
    s_add_u32 s13, s13, s14
    s_mul_i32 s13, s13, 18432
    s_lshl_b32 s14, s10, 7
    s_add_u32 s13, s13, s14
    s_and_b32 s14, s44, 1
    s_lshl_b32 s14, s14, 6
    s_add_u32 s13, s13, s14
    v_and_b32 v5, 15, v0
    v_mul_u32_u24 v5, 1152, v5
    v_lshrrev_b32 v6, 4, v0
    v_lshl_add_u32 v5, v6, 4, v5
    buffer_store_dwordx4 v[8:11], v5, s[20:23], s13 offen
.Lk2_end:
    s_endpgm
.section .rodata,"a"
.p2align 6
.amdhsa_kernel attn_kernel
  .amdhsa_next_free_vgpr 256
  .amdhsa_next_free_sgpr 64
  .amdhsa_accum_offset 256
  .amdhsa_group_segment_fixed_size 0
  .amdhsa_kernarg_size 64
  .amdhsa_user_sgpr_count 2
  .amdhsa_user_sgpr_kernarg_segment_ptr 1
  .amdhsa_system_sgpr_workgroup_id_x 1
.end_amdhsa_kernel
.p2align 6
.amdhsa_kernel oproj_kernel
  .amdhsa_next_free_vgpr 256
  .amdhsa_next_free_sgpr 64
  .amdhsa_accum_offset 256
  .amdhsa_group_segment_fixed_size 0
  .amdhsa_kernarg_size 64
  .amdhsa_user_sgpr_count 2
  .amdhsa_user_sgpr_kernarg_segment_ptr 1
  .amdhsa_system_sgpr_workgroup_id_x 1
.end_amdhsa_kernel
```
